```python
import torch

def _softmax(x, axis=-1):
    return torch.softmax(x, dim=axis)
def _gelu(x):
    return torch.nn.functional.gelu(x, approximate="tanh")
def _silu(x):
    return torch.nn.functional.silu(x)
def _sigmoid(x):
    return torch.sigmoid(x)
def _layernorm(x, axis=-1, eps=1e-5):
    m = x.mean(dim=axis, keepdim=True)
    v = x.var(dim=axis, keepdim=True, unbiased=False)
    return (x - m) / torch.sqrt(v + eps)
def _scatter_add(tgt, idx, src, axis=0):
    return tgt.clone().index_add_(axis, idx, src)
def _segment_sum(src, seg, n):
    out = torch.zeros((n,) + src.shape[1:], dtype=src.dtype)
    return out.index_add_(0, seg, src)
def _pad(x, pw):
    flat = tuple(v for pair in reversed(pw) for v in pair)
    return torch.nn.functional.pad(x, flat)

kernel_name = 'gated_mix__compressed_kv_cla__sliding_block_cached__decode'

def setup_inputs():

    _w = (lambda a: (lambda t: t.to(torch.bfloat16) if t.is_floating_point() else t)(torch.as_tensor(a)))
    def _A_setup():
        B, H, Sq, Sk, D, M = 8, 32, 1, 4096, 128, 512
        Dc = 4 * D
        return {
            "x": _w((lambda *s: torch.randn(*s, dtype=torch.bfloat16) * 0.05)(B, Sq, M)),
            "c_kv": _w((lambda *s: torch.randn(*s, dtype=torch.bfloat16) * 0.4)(B, Sk, Dc)),
            "w_q": _w((lambda *s: torch.randn(*s, dtype=torch.bfloat16) * 6.4)(M, H, D) * (M ** -0.5)),
            "w_uk": _w((lambda *s: torch.randn(*s, dtype=torch.bfloat16) * 6.4)(Dc, H, D) * (Dc ** -0.5)),
            "w_uv": _w((lambda *s: torch.randn(*s, dtype=torch.bfloat16) * 0.4)(Dc, H, D) * (Dc ** -0.5)),
            "w_o": _w((lambda *s: torch.randn(*s, dtype=torch.bfloat16) * 0.4)(H, D, M) * ((H * D) ** -0.5)),
        }
    _A_in = _A_setup()

    def _B_setup():
        B, Sq, D = 8, 1, 512
        Hq, Hkv, Sk, Dh = 32, 8, 4096, 128
        assert Hq % Hkv == 0, (Hq, Hkv)
        return {
            "x": _w((lambda *s: torch.randn(*s, dtype=torch.bfloat16) * 0.05)(B, Sq, D)),
            "k_cache": _w((lambda *s: torch.randn(*s, dtype=torch.bfloat16) * 6.4)(B, Hkv, Sk, Dh)),
            "v_cache": _w((lambda *s: torch.randn(*s, dtype=torch.bfloat16) * 0.05)(B, Hkv, Sk, Dh)),
            "wq": _w((lambda *s: torch.randn(*s, dtype=torch.bfloat16) * 6.4)(D, Hq * Dh) * (D ** -0.5)),
            "wo": _w((lambda *s: torch.randn(*s, dtype=torch.bfloat16) * 0.05)(Hq * Dh, D) * ((Hq * Dh) ** -0.5)),
        }
    _B_in = _B_setup()

    return {
        "A_x": _A_in["x"],
        "A_c_kv": _A_in["c_kv"],
        "A_w_q": _A_in["w_q"],
        "A_w_uk": _A_in["w_uk"],
        "A_w_uv": _A_in["w_uv"],
        "A_w_o": _A_in["w_o"],
        "B_x": _B_in["x"],
        "B_k_cache": _B_in["k_cache"],
        "B_v_cache": _B_in["v_cache"],
        "B_wq": _B_in["wq"],
        "B_wo": _B_in["wo"],
        "gate_w": _w((lambda *s: torch.randn(*s, dtype=torch.bfloat16) * 0.05)(512) * 16.0),
    }

def reference(A_x, A_c_kv, A_w_q, A_w_uk, A_w_uv, A_w_o, B_x, B_k_cache, B_v_cache, B_wq, B_wo, gate_w):
    def _A_ref(x, c_kv, w_q, w_uk, w_uv, w_o):
        B, Sq, M = x.shape[0], x.shape[1], x.shape[2]
        Sk = c_kv.shape[1]
        H, D = w_q.shape[1], w_q.shape[2]
        q = torch.einsum("bqm,mhd->bhqd", x, w_q)
        k = torch.einsum("bkc,chd->bhkd", c_kv, w_uk)
        v = torch.einsum("bkc,chd->bhkd", c_kv, w_uv)
        scores = torch.einsum("bhqd,bhkd->bhqk", q, k) * (D ** -0.5)
        off = Sk - Sq
        qi = torch.arange(Sq)[:, None]
        kj = torch.arange(Sk)[None, :]
        cmask = kj <= (qi + off)
        scores = torch.where(cmask[None, None], scores, -1e9)
        p = _softmax(scores, axis=-1)
        ctx = torch.einsum("bhqk,bhkd->bhqd", p, v)
        return torch.einsum("bhqd,hdm->bqm", ctx, w_o)

    def _B_ref(x, k_cache, v_cache, wq, wo):
        B, Sq, D = x.shape
        Hq, Dh = 32, 128
        Hkv, Sk = k_cache.shape[1], k_cache.shape[2]
        W = min(4096, max(256, Sk // 4))
        rep = Hq // Hkv
        q = (lambda x, *d: x.permute(*d))((x @ wq).reshape(B, Sq, Hq, Dh), 0, 2, 1, 3)
        k = (lambda x, n, axis: torch.repeat_interleave(x, n, dim=axis))(k_cache[:, :, Sk - W:, :], rep, axis=1)
        v = (lambda x, n, axis: torch.repeat_interleave(x, n, dim=axis))(v_cache[:, :, Sk - W:, :], rep, axis=1)
        scores = torch.einsum("bhqd,bhkd->bhqk", q, k) * (Dh ** -0.5)
        p = _softmax(scores, axis=-1)
        o = torch.einsum("bhqk,bhkd->bhqd", p, v)
        return (lambda x, *d: x.permute(*d))(o, 0, 2, 1, 3).reshape(B, Sq, Hq * Dh) @ wo

    x = A_x
    g = _sigmoid((x * gate_w).sum(-1, keepdims=True))
    a = _A_ref(x, A_c_kv, A_w_q, A_w_uk, A_w_uv, A_w_o)
    b = _B_ref(x, B_k_cache, B_v_cache, B_wq, B_wo)
    return g * a + (1 - g) * b
```

```asm
; @launch grid=(256,1,1) block=(512,1,1) lds=163840
.amdgcn_target "amdgcn-amd-amdhsa--gfx950"
.text
.globl gated_mix__compressed_kv_cla__sliding_block_cached__decode_kernel
.p2align 8
.type gated_mix__compressed_kv_cla__sliding_block_cached__decode_kernel,@function
gated_mix__compressed_kv_cla__sliding_block_cached__decode_kernel:
    s_cmp_ge_u32 s2, 256
    s_cbranch_scc1 L_end
    s_load_dwordx16 s[48:63], s[0:1], 0
    s_load_dwordx8 s[64:71], s[0:1], 64
    s_load_dwordx4 s[72:75], s[0:1], 96
    s_load_dwordx2 s[76:77], s[0:1], 112
    v_lshrrev_b32 v2, 6, v0
    v_and_b32 v1, 63, v0
    v_readfirstlane_b32 s3, v2
    s_and_b32 s7, s2, 7
    s_lshr_b32 s4, s2, 4
    s_lshr_b32 s88, s4, 2
    s_lshl2_add_u32 s88, s7, s88
    s_and_b32 s89, s4, 3
    s_getreg_b32 s95, hwreg(HW_REG_XCC_ID, 0, 4)
    s_mov_b32 s98, 0x05040100
    s_mov_b32 s99, 0x07060302
    s_mov_b32 s6, 30000
    s_mov_b32 s90, 0x0c04000c
    s_mov_b32 s91, 0x0402010c
    s_mov_b32 s92, 0x07060501
    s_mov_b32 s93, 0x07060502
    s_mov_b32 s94, 0x07060503
    s_mov_b32 s96, 0x00ff00ff
    s_mov_b32 s97, 0x00ff00ff
    v_lshrrev_b32 v5, 4, v1
    v_and_b32 v6, 15, v1
    v_lshlrev_b32 v7, 4, v1
    v_and_b32 v4, 7, v1
    s_bitcmp1_b32 s2, 3
    s_cbranch_scc0 L_A
    s_lshl_b32 s78, s3, 17
    s_lshl_b32 s79, s88, 8
    s_lshl_b32 s87, s89, 20
    s_add_u32 s87, s87, s78
    s_lshr_b32 s84, s87, 12
    s_add_u32 s87, s87, s79
    v_lshlrev_b32 v152, 15, v5
    v_lshl_add_u32 v152, v6, 4, v152
    v_add_u32 v153, 8192, v152
    v_add_u32 v154, 16384, v152
    v_add_u32 v155, 24576, v152
    v_xor_b32 v2, v6, v5
    v_lshlrev_b32 v2, 4, v2
    v_lshl_add_u32 v140, v5, 13, v2
    v_xor_b32 v141, 32832, v140
    v_xor_b32 v142, 65664, v140
    v_xor_b32 v143, 98496, v140
    s_lshl_b32 s78, s3, 12
    s_add_u32 s78, s78, 57344
    s_mov_b32 m0, s78
    v_lshl_add_u32 v2, v6, 8, v2
    v_add_u32 v144, s78, v2
    v_lshlrev_b32 v3, 10, v4
    v_lshl_add_u32 v3, v5, 3, v3
    s_waitcnt lgkmcnt(0)
    s_mov_b64 s[12:13], s[52:53]
    s_mov_b32 s14, 0x400000
    s_mov_b32 s15, 0x00020000
    buffer_load_dwordx4 v[160:163], v152, s[12:15], s87 offen nt
    buffer_load_dwordx4 v[164:167], v153, s[12:15], s87 offen nt
    buffer_load_dwordx4 v[168:171], v154, s[12:15], s87 offen nt
    buffer_load_dwordx4 v[172:175], v155, s[12:15], s87 offen nt
    s_mov_b64 s[32:33], s[48:49]
    s_mov_b32 s34, 0x2000
    s_mov_b32 s35, 0x00020000
    buffer_load_dwordx2 v[176:177], v3, s[32:35], s84 offen
    s_add_u32 s76, s76, 0xffffff
    s_addc_u32 s77, s77, 0
    s_and_b32 s76, s76, 0xff000000
    s_load_dword s5, s[76:77], 0
    s_mov_b64 s[16:17], s[54:55]
    s_mov_b32 s18, 0x400000
    s_mov_b32 s19, 0x00020000
    s_barrier
    buffer_load_dwordx4 v140, s[16:19], s87 offen nt lds
    s_add_u32 m0, m0, 1024
    s_nop 0
    buffer_load_dwordx4 v141, s[16:19], s87 offen nt lds
    s_add_u32 m0, m0, 1024
    s_nop 0
    buffer_load_dwordx4 v142, s[16:19], s87 offen nt lds
    s_add_u32 m0, m0, 1024
    s_nop 0
    buffer_load_dwordx4 v143, s[16:19], s87 offen nt lds
    s_add_u32 m0, m0, 1024
    s_mov_b64 s[44:45], s[66:67]
    s_mov_b32 s46, 0x400000
    s_mov_b32 s47, 0x00020000
    s_mov_b64 s[8:9], s[76:77]
    s_mov_b32 s10, 0xa00000
    s_mov_b32 s11, 0x00020000
    s_mov_b64 s[40:41], s[72:73]
    s_mov_b32 s42, 0x2000
    s_mov_b32 s43, 0x00020000
    s_mov_b64 s[20:21], s[68:69]
    s_mov_b32 s22, 0x400000
    s_mov_b32 s23, 0x00020000
    s_mov_b64 s[24:25], s[62:63]
    s_mov_b32 s26, 0x4000000
    s_mov_b32 s27, 0x00020000
    s_mov_b64 s[28:29], s[64:65]
    s_mov_b32 s30, 0x4000000
    s_mov_b32 s31, 0x00020000
    s_mov_b64 s[36:37], s[70:71]
    s_mov_b32 s38, 0x400
    s_mov_b32 s39, 0x00020000
    s_mov_b64 s[12:13], s[50:51]
    s_mov_b32 s14, 0x2000000
    s_mov_b32 s15, 0x00020000
    s_lshl4_add_u32 s79, s7, s4
    s_lshl_b32 s79, s79, 18
    s_lshl_b32 s78, s3, 13
    v_lshl_add_u32 v136, v1, 7, s79
    v_add_u32 v137, s78, v136
    v_add_u32 v136, s78, v137
    v_xor_b32 v145, 64, v144
    v_xor_b32 v146, 128, v144
    v_xor_b32 v147, 192, v144
    s_mul_i32 s84, s3, 4352
    v_mul_u32_u24 v2, 272, v5
    v_lshl_add_u32 v2, v6, 4, v2
    v_add_u32 v156, s84, v2
    v_mul_u32_u24 v149, 272, v6
    v_bfe_u32 v2, v1, 4, 1
    v_lshl_add_u32 v149, v2, 7, v149
    v_bfe_u32 v2, v0, 5, 3
    v_lshl_add_u32 v149, v2, 4, v149
    v_and_b32 v3, 31, v1
    v_lshlrev_b32 v3, 4, v3
    v_lshl_add_u32 v150, v2, 13, v3
    v_lshl_add_u32 v157, v2, 9, v3
    v_mul_u32_u24 v158, 272, v2
    v_and_b32 v2, 3, v1
    v_lshl_add_u32 v158, v2, 6, v158
    v_bfe_u32 v2, v1, 2, 3
    v_lshl_add_u32 v158, v2, 1, v158
    v_mul_u32_u24 v159, 272, v4
    v_lshl_add_u32 v159, v5, 4, v159
    v_lshlrev_b32 v148, 16, v4
    v_lshl_add_u32 v148, v5, 4, v148
    s_lshl_b32 s84, s88, 11
    s_lshl_b32 s85, s89, 9
    s_add_u32 s84, s84, s85
    s_lshl_b32 s85, s3, 6
    s_add_u32 s84, s84, s85
    s_add_u32 s84, s84, 1114112
    s_lshl_b32 s85, s88, 14
    s_add_u32 s85, s85, 65536
    s_add_u32 s80, s89, 0
    s_and_b32 s80, s80, 3
    s_lshl_b32 s80, s80, 12
    s_add_u32 s80, s80, s85
    s_add_u32 s81, s89, 1
    s_and_b32 s81, s81, 3
    s_lshl_b32 s81, s81, 12
    s_add_u32 s81, s81, s85
    s_add_u32 s82, s89, 2
    s_and_b32 s82, s82, 3
    s_lshl_b32 s82, s82, 12
    s_add_u32 s82, s82, s85
    s_add_u32 s83, s89, 3
    s_and_b32 s83, s83, 3
    s_lshl_b32 s83, s83, 12
    s_add_u32 s83, s83, s85
    s_waitcnt vmcnt(7)
    v_perm_b32 v192, v164, v160, s98
    v_perm_b32 v194, v164, v160, s99
    v_perm_b32 v196, v165, v161, s98
    v_perm_b32 v198, v165, v161, s99
    v_perm_b32 v200, v166, v162, s98
    v_perm_b32 v202, v166, v162, s99
    v_perm_b32 v204, v167, v163, s98
    v_perm_b32 v206, v167, v163, s99
    s_waitcnt vmcnt(5)
    v_perm_b32 v193, v172, v168, s98
    v_perm_b32 v195, v172, v168, s99
    v_perm_b32 v197, v173, v169, s98
    v_perm_b32 v199, v173, v169, s99
    v_perm_b32 v201, v174, v170, s98
    v_perm_b32 v203, v174, v170, s99
    v_perm_b32 v205, v175, v171, s98
    v_perm_b32 v207, v175, v171, s99
    s_waitcnt vmcnt(4)
    v_cndmask_b32 v184, v176, 0, s[96:97]
    v_cndmask_b32 v185, v177, 0, s[96:97]
    v_cndmask_b32 v176, 0, v176, s[96:97]
    v_cndmask_b32 v177, 0, v177, s[96:97]
    s_nop 1
    v_mfma_f32_16x16x16_bf16 v[224:227], v[192:193], v[176:177], 0
    v_mfma_f32_16x16x16_bf16 v[228:231], v[194:195], v[176:177], 0
    v_mfma_f32_16x16x16_bf16 v[232:235], v[196:197], v[176:177], 0
    v_mfma_f32_16x16x16_bf16 v[236:239], v[198:199], v[176:177], 0
    v_mfma_f32_16x16x16_bf16 v[224:227], v[200:201], v[184:185], v[224:227]
    v_mfma_f32_16x16x16_bf16 v[228:231], v[202:203], v[184:185], v[228:231]
    v_mfma_f32_16x16x16_bf16 v[232:235], v[204:205], v[184:185], v[232:235]
    v_mfma_f32_16x16x16_bf16 v[236:239], v[206:207], v[184:185], v[236:239]
    s_nop 4
    ds_write_b128 v156, v[224:227] offset:0
    ds_write_b128 v156, v[228:231] offset:1088
    ds_write_b128 v156, v[232:235] offset:2176
    ds_write_b128 v156, v[236:239] offset:3264
    s_waitcnt lgkmcnt(0)
    s_add_u32 s5, s5, 0x9e3779b9
    s_add_u32 s95, s95, s5
    s_barrier
    s_cmp_lt_u32 s3, 4
    s_cbranch_scc1 L_B_lo
    ds_read_b128 v[192:195], v149 offset:0
    ds_read_b128 v[196:199], v149 offset:4352
    ds_read_b128 v[200:203], v149 offset:8704
    ds_read_b128 v[204:207], v149 offset:13056
    ds_read_b128 v[208:211], v149 offset:17408
    ds_read_b128 v[212:215], v149 offset:21760
    ds_read_b128 v[216:219], v149 offset:26112
    ds_read_b128 v[220:223], v149 offset:30464
    v_mov_b32 v227, s5
    s_waitcnt lgkmcnt(6)
    v_pk_add_f32 v[192:193], v[192:193], v[196:197]
    v_pk_add_f32 v[194:195], v[194:195], v[198:199]
    s_waitcnt lgkmcnt(4)
    v_pk_add_f32 v[200:201], v[200:201], v[204:205]
    v_pk_add_f32 v[202:203], v[202:203], v[206:207]
    v_pk_add_f32 v[192:193], v[192:193], v[200:201]
    v_pk_add_f32 v[194:195], v[194:195], v[202:203]
    s_waitcnt lgkmcnt(2)
    v_pk_add_f32 v[208:209], v[208:209], v[212:213]
    v_pk_add_f32 v[210:211], v[210:211], v[214:215]
    s_waitcnt lgkmcnt(0)
    v_pk_add_f32 v[216:217], v[216:217], v[220:221]
    v_pk_add_f32 v[218:219], v[218:219], v[222:223]
    v_pk_add_f32 v[208:209], v[208:209], v[216:217]
    v_pk_add_f32 v[210:211], v[210:211], v[218:219]
    v_pk_add_f32 v[192:193], v[192:193], v[208:209]
    v_pk_add_f32 v[194:195], v[194:195], v[210:211]
    v_perm_b32 v224, v192, v195, s92
    v_perm_b32 v225, v193, v195, s93
    v_perm_b32 v226, v194, v195, s94
    buffer_store_dwordx4 v[224:227], v157, s[8:11], s80 offen sc1
    s_sleep 32
    s_mov_b32 s86, 0x3e0293ee
    s_mov_b32 s85, s86
    buffer_load_dwordx4 v[228:231], v157, s[8:11], s81 offen sc1
    buffer_load_dwordx4 v[232:235], v157, s[8:11], s82 offen sc1
    buffer_load_dwordx4 v[236:239], v157, s[8:11], s83 offen sc1
    s_waitcnt vmcnt(0)
L_poll_1:
    s_mov_b64 s[0:1], exec
    v_cmpx_eq_u32 vcc, s5, v231
    v_cmpx_eq_u32 vcc, s5, v235
    v_cmpx_eq_u32 vcc, s5, v239
    s_andn2_b64 exec, s[0:1], exec
    s_cbranch_scc0 L_got_2
    buffer_load_dwordx4 v[228:231], v157, s[8:11], s81 offen sc1
    buffer_load_dwordx4 v[232:235], v157, s[8:11], s82 offen sc1
    buffer_load_dwordx4 v[236:239], v157, s[8:11], s83 offen sc1
    s_sub_u32 s6, s6, 1
    s_cmp_gt_i32 s6, 0
    s_waitcnt vmcnt(0)
    s_cbranch_scc1 L_poll_1
L_got_2:
    s_mov_b64 exec, -1
    s_nop 3
    ds_read_b128 v[56:59], v144
    ds_read_b128 v[60:63], v145
    ds_read_b128 v[64:67], v146
    ds_read_b128 v[68:71], v147
    v_perm_b32 v227, v225, v224, s90
    v_perm_b32 v227, v226, v227, s91
    v_perm_b32 v231, v229, v228, s90
    v_perm_b32 v231, v230, v231, s91
    v_perm_b32 v235, v233, v232, s90
    v_perm_b32 v235, v234, v235, s91
    v_perm_b32 v239, v237, v236, s90
    v_perm_b32 v239, v238, v239, s91
    v_pk_add_f32 v[224:225], v[224:225], v[228:229]
    v_pk_add_f32 v[232:233], v[232:233], v[236:237]
    v_pk_add_f32 v[226:227], v[226:227], v[230:231]
    v_pk_add_f32 v[234:235], v[234:235], v[238:239]
    v_pk_add_f32 v[224:225], v[224:225], v[232:233]
    v_pk_add_f32 v[226:227], v[226:227], v[234:235]
    v_mul_f32 v224, s86, v224
    v_mul_f32 v225, s86, v225
    v_mul_f32 v226, s86, v226
    v_mul_f32 v227, s86, v227
    v_cvt_pk_bf16_f32 v224, v224, v225
    v_cvt_pk_bf16_f32 v225, v226, v227
    ds_write_b16 v158, v224 offset:34816
    ds_write_b16_d16_hi v158, v224 offset:34832
    ds_write_b16 v158, v225 offset:34848
    ds_write_b16_d16_hi v158, v225 offset:34864
    s_branch L_B_b2
L_B_lo:
    s_waitcnt vmcnt(0)
    ds_read_b128 v[56:59], v144
    ds_read_b128 v[60:63], v145
    ds_read_b128 v[64:67], v146
    ds_read_b128 v[68:71], v147
L_B_b2:
    v_bfe_u32 v3, v1, 2, 2
    v_lshlrev_b32 v3, 8, v3
    v_lshl_add_u32 v3, v5, 6, v3
    v_and_b32 v2, 3, v1
    v_lshl_add_u32 v151, v2, 4, v3
    v_mov_b32 v231, s5
    s_waitcnt lgkmcnt(0)
    s_barrier
    s_cmp_lg_u32 s3, 0
    s_cbranch_scc1 L_B_nh
    s_lshl4_add_u32 s78, s7, s4
    s_lshl_b32 s78, s78, 2
    s_add_u32 s78, s78, 8192
    v_lshlrev_b32 v2, 9, v1
    s_mov_b64 exec, 0xff
    buffer_store_dword v231, v2, s[8:11], s78 offen sc1
    s_mov_b64 exec, -1
L_B_nh:
    ds_read_b128 v[192:195], v159 offset:34816
    ds_read_b128 v[196:199], v159 offset:34880
    ds_read_b128 v[200:203], v159 offset:34944
    ds_read_b128 v[204:207], v159 offset:35008
    s_lshr_b32 s78, s4, 1
    s_lshl3_add_u32 s80, s78, s7
    s_lshl_b32 s80, s80, 20
    s_and_b32 s81, s4, 1
    s_lshl_b32 s81, s81, 17
    s_add_u32 s80, s80, s81
    s_lshl_b32 s81, s3, 14
    s_add_u32 s80, s80, s81
    s_add_u32 s80, s80, 786432
    s_add_u32 s81, s80, 4096
    s_add_u32 s82, s80, 8192
    s_add_u32 s83, s80, 12288
    s_waitcnt lgkmcnt(3)
    v_mfma_f32_16x16x32_bf16 v[224:227], v[56:59], v[192:195], 0
    s_waitcnt lgkmcnt(2)
    v_mfma_f32_16x16x32_bf16 v[232:235], v[60:63], v[196:199], 0
    s_waitcnt lgkmcnt(1)
    v_mfma_f32_16x16x32_bf16 v[224:227], v[64:67], v[200:203], v[224:227]
    s_waitcnt lgkmcnt(0)
    v_mfma_f32_16x16x32_bf16 v[232:235], v[68:71], v[204:207], v[232:235]
    s_nop 7
    v_pk_add_f32 v[224:225], v[224:225], v[232:233]
    v_pk_add_f32 v[226:227], v[226:227], v[234:235]
    v_cvt_pk_bf16_f32 v228, v224, v225
    v_cvt_pk_bf16_f32 v229, v226, v227
    s_mov_b64 exec, s[96:97]
    buffer_store_dwordx4 v[228:231], v148, s[8:11], s84 offen sc1
    s_mov_b64 exec, -1
    buffer_load_dwordx4 v[160:163], v152, s[44:47], s87 offen nt
    buffer_load_dwordx4 v[164:167], v153, s[44:47], s87 offen nt
    buffer_load_dwordx4 v[168:171], v154, s[44:47], s87 offen nt
    buffer_load_dwordx4 v[172:175], v155, s[44:47], s87 offen nt
    s_waitcnt vmcnt(2)
    buffer_load_dwordx4 v[8:11], v151, s[24:27], s80 offen offset:0 nt
    s_waitcnt vmcnt(2)
    buffer_load_dwordx4 v[12:15], v151, s[24:27], s80 offen offset:1024 nt
    s_waitcnt vmcnt(2)
    buffer_load_dwordx4 v[16:19], v151, s[24:27], s80 offen offset:2048 nt
    s_cmp_lg_u32 s3, 6
    s_cbranch_scc1 L_nxt_3
    s_lshl_b32 s78, s7, 7
    s_bfe_u32 s79, s2, 0x10003
    s_lshl_b32 s79, s79, 11
    s_add_u32 s78, s78, s79
    s_lshl2_add_u32 s78, s4, s78
    v_mov_b32 v2, s95
    v_mov_b32 v3, 0
    s_mov_b64 exec, 1
    s_add_u32 s78, s78, 4096
    buffer_store_dword v2, v3, s[8:11], s78 offen sc1
    s_mov_b64 exec, -1
L_nxt_3:
    s_lshl_b32 s84, s7, 16
    s_add_u32 s84, s84, 589824
    s_lshl_b32 s85, s4, 9
    s_add_u32 s85, s85, s84
    s_waitcnt vmcnt(5)
    v_perm_b32 v192, v164, v160, s98
    v_perm_b32 v194, v164, v160, s99
    v_perm_b32 v196, v165, v161, s98
    v_perm_b32 v198, v165, v161, s99
    v_perm_b32 v200, v166, v162, s98
    v_perm_b32 v202, v166, v162, s99
    v_perm_b32 v204, v167, v163, s98
    v_perm_b32 v206, v167, v163, s99
    s_waitcnt vmcnt(3)
    v_perm_b32 v193, v172, v168, s98
    v_perm_b32 v195, v172, v168, s99
    v_perm_b32 v197, v173, v169, s98
    v_perm_b32 v199, v173, v169, s99
    v_perm_b32 v201, v174, v170, s98
    v_perm_b32 v203, v174, v170, s99
    v_perm_b32 v205, v175, v171, s98
    v_perm_b32 v207, v175, v171, s99
    v_mfma_f32_16x16x16_bf16 v[224:227], v[192:193], v[176:177], 0
    v_mfma_f32_16x16x16_bf16 v[228:231], v[194:195], v[176:177], 0
    v_mfma_f32_16x16x16_bf16 v[232:235], v[196:197], v[176:177], 0
    v_mfma_f32_16x16x16_bf16 v[236:239], v[198:199], v[176:177], 0
    v_mfma_f32_16x16x16_bf16 v[224:227], v[200:201], v[184:185], v[224:227]
    v_mfma_f32_16x16x16_bf16 v[228:231], v[202:203], v[184:185], v[228:231]
    v_mfma_f32_16x16x16_bf16 v[232:235], v[204:205], v[184:185], v[232:235]
    v_mfma_f32_16x16x16_bf16 v[236:239], v[206:207], v[184:185], v[236:239]
    s_nop 4
    ds_write_b128 v156, v[224:227] offset:0
    ds_write_b128 v156, v[228:231] offset:1088
    ds_write_b128 v156, v[232:235] offset:2176
    ds_write_b128 v156, v[236:239] offset:3264
    v_and_b32 v3, 31, v1
    v_lshlrev_b32 v3, 4, v3
    v_lshrrev_b32 v2, 5, v1
    v_lshl_add_u32 v146, v2, 11, v3
    v_lshrrev_b32 v2, 5, v0
    v_lshlrev_b32 v2, 8, v2
    v_and_b32 v3, 3, v1
    v_lshl_add_u32 v2, v3, 6, v2
    v_bfe_u32 v3, v1, 2, 3
    v_lshl_add_u32 v147, v3, 1, v2
    s_lshr_b32 s86, s4, 1
    s_lshl_b32 s86, s86, 13
    s_add_u32 s84, s84, s86
    s_lshl_b32 s86, s3, 12
    s_add_u32 s84, s84, s86
    s_add_u32 m0, s86, 90112
    v_lshlrev_b32 v2, 1, v5
    v_xor_b32 v2, v2, v6
    v_lshlrev_b32 v2, 4, v2
    v_lshl_add_u32 v140, v5, 10, v2
    v_xor_b32 v141, 128, v140
    s_lshl_b32 s86, s88, 17
    s_lshl_b32 s87, s3, 14
    s_add_u32 s86, s86, s87
    s_lshl_b32 s87, s89, 8
    s_add_u32 s86, s86, s87
    s_waitcnt lgkmcnt(0)
    s_barrier
    s_cmp_lt_u32 s3, 4
    s_cbranch_scc1 L_B_nr
    ds_read_b128 v[192:195], v149 offset:0
    ds_read_b128 v[196:199], v149 offset:4352
    ds_read_b128 v[200:203], v149 offset:8704
    ds_read_b128 v[204:207], v149 offset:13056
    ds_read_b128 v[208:211], v149 offset:17408
    ds_read_b128 v[212:215], v149 offset:21760
    ds_read_b128 v[216:219], v149 offset:26112
    ds_read_b128 v[220:223], v149 offset:30464
    v_mov_b32 v227, s5
    s_waitcnt lgkmcnt(6)
    v_pk_add_f32 v[192:193], v[192:193], v[196:197]
    v_pk_add_f32 v[194:195], v[194:195], v[198:199]
    s_waitcnt lgkmcnt(4)
    v_pk_add_f32 v[200:201], v[200:201], v[204:205]
    v_pk_add_f32 v[202:203], v[202:203], v[206:207]
    v_pk_add_f32 v[192:193], v[192:193], v[200:201]
    v_pk_add_f32 v[194:195], v[194:195], v[202:203]
    s_waitcnt lgkmcnt(2)
    v_pk_add_f32 v[208:209], v[208:209], v[212:213]
    v_pk_add_f32 v[210:211], v[210:211], v[214:215]
    s_waitcnt lgkmcnt(0)
    v_pk_add_f32 v[216:217], v[216:217], v[220:221]
    v_pk_add_f32 v[218:219], v[218:219], v[222:223]
    v_pk_add_f32 v[208:209], v[208:209], v[216:217]
    v_pk_add_f32 v[210:211], v[210:211], v[218:219]
    v_pk_add_f32 v[192:193], v[192:193], v[208:209]
    v_pk_add_f32 v[194:195], v[194:195], v[210:211]
    v_perm_b32 v224, v192, v195, s92
    v_perm_b32 v225, v193, v195, s93
    v_perm_b32 v226, v194, v195, s94
    buffer_store_dwordx4 v[224:227], v150, s[8:11], s85 offen sc1
L_B_nr:
    s_waitcnt vmcnt(2)
    buffer_load_dwordx4 v[20:23], v151, s[24:27], s80 offen offset:3072 nt
    s_waitcnt vmcnt(2)
    buffer_load_dwordx4 v[24:27], v151, s[24:27], s81 offen offset:0 nt
    s_waitcnt vmcnt(2)
    buffer_load_dwordx4 v[28:31], v151, s[24:27], s81 offen offset:1024 nt
    s_waitcnt vmcnt(2)
    buffer_load_dwordx4 v[32:35], v151, s[24:27], s81 offen offset:2048 nt
    s_waitcnt vmcnt(2)
    buffer_load_dwordx4 v[36:39], v151, s[24:27], s81 offen offset:3072 nt
    s_waitcnt vmcnt(2)
    buffer_load_dwordx4 v[40:43], v151, s[24:27], s82 offen offset:0 nt
    s_waitcnt vmcnt(2)
    buffer_load_dwordx4 v[44:47], v151, s[24:27], s82 offen offset:1024 nt
    s_waitcnt vmcnt(2)
    buffer_load_dwordx4 v[48:51], v151, s[24:27], s82 offen offset:2048 nt
    s_waitcnt vmcnt(2)
    buffer_load_dwordx4 v[52:55], v151, s[24:27], s82 offen offset:3072 nt
    s_waitcnt vmcnt(5)
    buffer_load_dwordx4 v[56:59], v151, s[24:27], s83 offen offset:0 nt
    s_waitcnt vmcnt(5)
    buffer_load_dwordx4 v[60:63], v151, s[24:27], s83 offen offset:1024 nt
    s_waitcnt vmcnt(5)
    buffer_load_dwordx4 v[64:67], v151, s[24:27], s83 offen offset:2048 nt
    s_waitcnt vmcnt(5)
    buffer_load_dwordx4 v[68:71], v151, s[24:27], s83 offen offset:3072 nt
    s_cmp_ge_u32 s3, 2
    s_cbranch_scc1 L_B_g1
    s_lshl_b32 s78, s7, 7
    s_bfe_u32 s79, s2, 0x10003
    s_lshl_b32 s79, s79, 11
    s_add_u32 s78, s78, s79
    s_add_u32 s78, s78, 4096
    v_lshlrev_b32 v2, 2, v6
    buffer_load_dword v240, v2, s[8:11], s78 offen sc1
    buffer_load_dwordx4 v[224:227], v146, s[8:11], s84 offen offset:0 sc1
    buffer_load_dwordx4 v[228:231], v146, s[8:11], s84 offen offset:512 sc1
    buffer_load_dwordx4 v[232:235], v146, s[8:11], s84 offen offset:1024 sc1
    buffer_load_dwordx4 v[236:239], v146, s[8:11], s84 offen offset:1536 sc1
L_B_g1:
    s_cmp_lg_u32 s3, 7
    s_cbranch_scc1 L_B_ng
    s_bfe_u32 s78, s2, 0x10003
    s_lshl_b32 s78, s78, 12
    v_lshrrev_b32 v2, 2, v1
    v_lshlrev_b32 v2, 6, v2
    v_and_b32 v3, 3, v1
    v_lshl_add_u32 v3, v3, 10, v2
    buffer_load_dwordx4 v[192:195], v3, s[32:35], s78 offen offset:0
    buffer_load_dwordx4 v[196:199], v3, s[32:35], s78 offen offset:16
    buffer_load_dwordx4 v[200:203], v3, s[32:35], s78 offen offset:32
    buffer_load_dwordx4 v[204:207], v3, s[32:35], s78 offen offset:48
    buffer_load_dwordx4 v[208:211], v2, s[36:39], 0 offen offset:0
    buffer_load_dwordx4 v[212:215], v2, s[36:39], 0 offen offset:16
    buffer_load_dwordx4 v[216:219], v2, s[36:39], 0 offen offset:32
    buffer_load_dwordx4 v[220:223], v2, s[36:39], 0 offen offset:48
L_B_ng:
    s_waitcnt vmcnt(5)
    buffer_load_dwordx4 v[72:75], v7, s[28:31], s80 offen offset:0 nt
    s_waitcnt vmcnt(5)
    buffer_load_dwordx4 v[76:79], v7, s[28:31], s80 offen offset:1024 nt
    s_waitcnt vmcnt(5)
    buffer_load_dwordx4 v[80:83], v7, s[28:31], s80 offen offset:2048 nt
    s_waitcnt vmcnt(5)
    buffer_load_dwordx4 v[84:87], v7, s[28:31], s80 offen offset:3072 nt
    s_cmp_ge_u32 s3, 2
    s_cbranch_scc1 L_B_g2
    s_waitcnt vmcnt(4)
L_poll_4:
    s_mov_b64 s[0:1], exec
    v_cmpx_eq_u32 vcc, s5, v227
    v_cmpx_eq_u32 vcc, s5, v231
    v_cmpx_eq_u32 vcc, s5, v235
    v_cmpx_eq_u32 vcc, s5, v239
    s_andn2_b64 exec, s[0:1], exec
    s_cbranch_scc0 L_got_5
    buffer_load_dwordx4 v[224:227], v146, s[8:11], s84 offen offset:0 sc1
    buffer_load_dwordx4 v[228:231], v146, s[8:11], s84 offen offset:512 sc1
    buffer_load_dwordx4 v[232:235], v146, s[8:11], s84 offen offset:1024 sc1
    buffer_load_dwordx4 v[236:239], v146, s[8:11], s84 offen offset:1536 sc1
    s_sub_u32 s6, s6, 1
    s_cmp_gt_i32 s6, 0
    s_waitcnt vmcnt(0)
    s_cbranch_scc1 L_poll_4
L_got_5:
    s_mov_b64 exec, -1
    s_nop 3
    v_cmp_eq_u32 vcc, s95, v240
    s_nop 1
    s_cmp_eq_u64 vcc, -1
    s_cselect_b32 s95, 1, 0
    v_perm_b32 v227, v225, v224, s90
    v_perm_b32 v227, v226, v227, s91
    v_perm_b32 v231, v229, v228, s90
    v_perm_b32 v231, v230, v231, s91
    v_perm_b32 v235, v233, v232, s90
    v_perm_b32 v235, v234, v235, s91
    v_perm_b32 v239, v237, v236, s90
    v_perm_b32 v239, v238, v239, s91
    v_pk_add_f32 v[224:225], v[224:225], v[228:229]
    v_pk_add_f32 v[232:233], v[232:233], v[236:237]
    v_pk_add_f32 v[226:227], v[226:227], v[230:231]
    v_pk_add_f32 v[234:235], v[234:235], v[238:239]
    v_pk_add_f32 v[224:225], v[224:225], v[232:233]
    v_pk_add_f32 v[226:227], v[226:227], v[234:235]
    v_cvt_pk_bf16_f32 v224, v224, v225
    v_cvt_pk_bf16_f32 v225, v226, v227
    ds_write_b16 v147, v224 offset:37120
    ds_write_b16_d16_hi v147, v224 offset:37136
    ds_write_b16 v147, v225 offset:37152
    ds_write_b16_d16_hi v147, v225 offset:37168
    s_waitcnt lgkmcnt(0)
L_B_g2:
    s_cmp_lg_u32 s3, 7
    s_cbranch_scc1 L_B_ng2
    s_waitcnt vmcnt(4)
    v_mov_b32 v2, 0
    v_mov_b32 v3, 0
    v_dot2c_f32_bf16 v2, v192, v208
    v_dot2c_f32_bf16 v3, v193, v209
    v_dot2c_f32_bf16 v2, v194, v210
    v_dot2c_f32_bf16 v3, v195, v211
    v_dot2c_f32_bf16 v2, v196, v212
    v_dot2c_f32_bf16 v3, v197, v213
    v_dot2c_f32_bf16 v2, v198, v214
    v_dot2c_f32_bf16 v3, v199, v215
    v_dot2c_f32_bf16 v2, v200, v216
    v_dot2c_f32_bf16 v3, v201, v217
    v_dot2c_f32_bf16 v2, v202, v218
    v_dot2c_f32_bf16 v3, v203, v219
    v_dot2c_f32_bf16 v2, v204, v220
    v_dot2c_f32_bf16 v3, v205, v221
    v_dot2c_f32_bf16 v2, v206, v222
    v_dot2c_f32_bf16 v3, v207, v223
    s_nop 3
    v_add_f32 v2, v2, v3
    s_nop 1
    v_add_f32_dpp v2, v2, v2 row_ror:4 row_mask:0xf bank_mask:0xf
    s_nop 1
    v_add_f32_dpp v2, v2, v2 row_ror:8 row_mask:0xf bank_mask:0xf
    v_mov_b32 v3, v2
    s_nop 1
    v_permlane16_swap_b32 v2, v3
    v_add_f32 v2, v2, v3
    v_mov_b32 v3, v2
    s_nop 1
    v_permlane32_swap_b32 v2, v3
    v_add_f32 v2, v2, v3
    v_mul_f32 v2, 0xbfb8aa3b, v2
    v_exp_f32 v2, v2
    s_nop 0
    v_add_f32 v2, 1.0, v2
    v_rcp_f32 v250, v2
L_B_ng2:
    s_barrier
    ds_read_b128 v[152:155], v151 offset:37120
    s_waitcnt vmcnt(5)
    buffer_load_dwordx4 v[88:91], v7, s[28:31], s81 offen offset:0 nt
    s_waitcnt vmcnt(5)
    buffer_load_dwordx4 v[92:95], v7, s[28:31], s81 offen offset:1024 nt
    s_waitcnt vmcnt(5)
    buffer_load_dwordx4 v[96:99], v7, s[28:31], s81 offen offset:2048 nt
    s_waitcnt vmcnt(5)
    buffer_load_dwordx4 v[100:103], v7, s[28:31], s81 offen offset:3072 nt
    s_waitcnt vmcnt(8)
    s_waitcnt lgkmcnt(0)
    v_mfma_f32_16x16x32_bf16 v[160:163], v[8:11], v[152:155], 0
    s_waitcnt vmcnt(5)
    buffer_load_dwordx4 v[104:107], v7, s[28:31], s82 offen offset:0 nt
    v_mfma_f32_16x16x32_bf16 v[164:167], v[12:15], v[152:155], 0
    s_waitcnt vmcnt(5)
    buffer_load_dwordx4 v[108:111], v7, s[28:31], s82 offen offset:1024 nt
    v_mfma_f32_16x16x32_bf16 v[168:171], v[16:19], v[152:155], 0
    s_nop 1
    v_mov_b32_dpp v200, v160 quad_perm:[0,0,0,0] row_mask:0xf bank_mask:0xf
    s_nop 1
    v_add_f32_dpp v200, v161, v200 quad_perm:[1,1,1,1] row_mask:0xf bank_mask:0xf
    s_nop 1
    v_add_f32_dpp v200, v162, v200 quad_perm:[2,2,2,2] row_mask:0xf bank_mask:0xf
    s_nop 1
    v_add_f32_dpp v200, v163, v200 quad_perm:[3,3,3,3] row_mask:0xf bank_mask:0xf
    s_waitcnt vmcnt(5)
    buffer_load_dwordx4 v[112:115], v7, s[28:31], s82 offen offset:2048 nt
    v_mfma_f32_16x16x32_bf16 v[172:175], v[20:23], v[152:155], 0
    v_mov_b32_dpp v201, v164 quad_perm:[0,0,0,0] row_mask:0xf bank_mask:0xf
    s_nop 1
    v_add_f32_dpp v201, v165, v201 quad_perm:[1,1,1,1] row_mask:0xf bank_mask:0xf
    s_nop 1
    v_add_f32_dpp v201, v166, v201 quad_perm:[2,2,2,2] row_mask:0xf bank_mask:0xf
    s_nop 1
    v_add_f32_dpp v201, v167, v201 quad_perm:[3,3,3,3] row_mask:0xf bank_mask:0xf
    s_waitcnt vmcnt(5)
    buffer_load_dwordx4 v[116:119], v7, s[28:31], s82 offen offset:3072 nt
    v_mfma_f32_16x16x32_bf16 v[160:163], v[24:27], v[152:155], 0
    v_mov_b32_dpp v202, v168 quad_perm:[0,0,0,0] row_mask:0xf bank_mask:0xf
    s_nop 1
    v_add_f32_dpp v202, v169, v202 quad_perm:[1,1,1,1] row_mask:0xf bank_mask:0xf
    s_nop 1
    v_add_f32_dpp v202, v170, v202 quad_perm:[2,2,2,2] row_mask:0xf bank_mask:0xf
    s_nop 1
    v_add_f32_dpp v202, v171, v202 quad_perm:[3,3,3,3] row_mask:0xf bank_mask:0xf
    s_waitcnt vmcnt(5)
    buffer_load_dwordx4 v[120:123], v7, s[28:31], s83 offen offset:0 nt
    v_mfma_f32_16x16x32_bf16 v[164:167], v[28:31], v[152:155], 0
    v_mov_b32_dpp v203, v172 quad_perm:[0,0,0,0] row_mask:0xf bank_mask:0xf
    s_nop 1
    v_add_f32_dpp v203, v173, v203 quad_perm:[1,1,1,1] row_mask:0xf bank_mask:0xf
    s_nop 1
    v_add_f32_dpp v203, v174, v203 quad_perm:[2,2,2,2] row_mask:0xf bank_mask:0xf
    s_nop 1
    v_add_f32_dpp v203, v175, v203 quad_perm:[3,3,3,3] row_mask:0xf bank_mask:0xf
    s_waitcnt vmcnt(5)
    buffer_load_dwordx4 v[124:127], v7, s[28:31], s83 offen offset:1024 nt
    v_mfma_f32_16x16x32_bf16 v[168:171], v[32:35], v[152:155], 0
    v_mov_b32_dpp v204, v160 quad_perm:[0,0,0,0] row_mask:0xf bank_mask:0xf
    s_nop 1
    v_add_f32_dpp v204, v161, v204 quad_perm:[1,1,1,1] row_mask:0xf bank_mask:0xf
    s_nop 1
    v_add_f32_dpp v204, v162, v204 quad_perm:[2,2,2,2] row_mask:0xf bank_mask:0xf
    s_nop 1
    v_add_f32_dpp v204, v163, v204 quad_perm:[3,3,3,3] row_mask:0xf bank_mask:0xf
    s_waitcnt vmcnt(5)
    buffer_load_dwordx4 v[128:131], v7, s[28:31], s83 offen offset:2048 nt
    v_mfma_f32_16x16x32_bf16 v[172:175], v[36:39], v[152:155], 0
    v_mov_b32_dpp v205, v164 quad_perm:[0,0,0,0] row_mask:0xf bank_mask:0xf
    s_nop 1
    v_add_f32_dpp v205, v165, v205 quad_perm:[1,1,1,1] row_mask:0xf bank_mask:0xf
    s_nop 1
    v_add_f32_dpp v205, v166, v205 quad_perm:[2,2,2,2] row_mask:0xf bank_mask:0xf
    s_nop 1
    v_add_f32_dpp v205, v167, v205 quad_perm:[3,3,3,3] row_mask:0xf bank_mask:0xf
    s_waitcnt vmcnt(5)
    buffer_load_dwordx4 v[132:135], v7, s[28:31], s83 offen offset:3072 nt
    v_mfma_f32_16x16x32_bf16 v[160:163], v[40:43], v[152:155], 0
    v_mov_b32_dpp v206, v168 quad_perm:[0,0,0,0] row_mask:0xf bank_mask:0xf
    s_nop 1
    v_add_f32_dpp v206, v169, v206 quad_perm:[1,1,1,1] row_mask:0xf bank_mask:0xf
    s_nop 1
    v_add_f32_dpp v206, v170, v206 quad_perm:[2,2,2,2] row_mask:0xf bank_mask:0xf
    s_nop 1
    v_add_f32_dpp v206, v171, v206 quad_perm:[3,3,3,3] row_mask:0xf bank_mask:0xf
    s_waitcnt vmcnt(5)
    buffer_load_dwordx4 v140, s[20:23], s86 offen nt lds
    s_add_u32 s86, s86, 4096
    s_add_u32 m0, m0, 1024
    v_mfma_f32_16x16x32_bf16 v[164:167], v[44:47], v[152:155], 0
    v_mov_b32_dpp v207, v172 quad_perm:[0,0,0,0] row_mask:0xf bank_mask:0xf
    s_nop 1
    v_add_f32_dpp v207, v173, v207 quad_perm:[1,1,1,1] row_mask:0xf bank_mask:0xf
    s_nop 1
    v_add_f32_dpp v207, v174, v207 quad_perm:[2,2,2,2] row_mask:0xf bank_mask:0xf
    s_nop 1
    v_add_f32_dpp v207, v175, v207 quad_perm:[3,3,3,3] row_mask:0xf bank_mask:0xf
    s_waitcnt vmcnt(5)
    buffer_load_dwordx4 v140, s[20:23], s86 offen nt lds
    s_add_u32 s86, s86, 4096
    s_add_u32 m0, m0, 1024
    v_mfma_f32_16x16x32_bf16 v[168:171], v[48:51], v[152:155], 0
    v_mov_b32_dpp v208, v160 quad_perm:[0,0,0,0] row_mask:0xf bank_mask:0xf
    s_nop 1
    v_add_f32_dpp v208, v161, v208 quad_perm:[1,1,1,1] row_mask:0xf bank_mask:0xf
    s_nop 1
    v_add_f32_dpp v208, v162, v208 quad_perm:[2,2,2,2] row_mask:0xf bank_mask:0xf
    s_nop 1
    v_add_f32_dpp v208, v163, v208 quad_perm:[3,3,3,3] row_mask:0xf bank_mask:0xf
    s_waitcnt vmcnt(5)
    buffer_load_dwordx4 v141, s[20:23], s86 offen nt lds
    s_add_u32 s86, s86, 4096
    s_add_u32 m0, m0, 1024
    v_mfma_f32_16x16x32_bf16 v[172:175], v[52:55], v[152:155], 0
    v_mov_b32_dpp v209, v164 quad_perm:[0,0,0,0] row_mask:0xf bank_mask:0xf
    s_nop 1
    v_add_f32_dpp v209, v165, v209 quad_perm:[1,1,1,1] row_mask:0xf bank_mask:0xf
    s_nop 1
    v_add_f32_dpp v209, v166, v209 quad_perm:[2,2,2,2] row_mask:0xf bank_mask:0xf
    s_nop 1
    v_add_f32_dpp v209, v167, v209 quad_perm:[3,3,3,3] row_mask:0xf bank_mask:0xf
    s_waitcnt vmcnt(5)
    buffer_load_dwordx4 v141, s[20:23], s86 offen nt lds
    v_mfma_f32_16x16x32_bf16 v[160:163], v[56:59], v[152:155], 0
    v_mov_b32_dpp v210, v168 quad_perm:[0,0,0,0] row_mask:0xf bank_mask:0xf
    s_nop 1
    v_add_f32_dpp v210, v169, v210 quad_perm:[1,1,1,1] row_mask:0xf bank_mask:0xf
    s_nop 1
    v_add_f32_dpp v210, v170, v210 quad_perm:[2,2,2,2] row_mask:0xf bank_mask:0xf
    s_nop 1
    v_add_f32_dpp v210, v171, v210 quad_perm:[3,3,3,3] row_mask:0xf bank_mask:0xf
    v_mfma_f32_16x16x32_bf16 v[164:167], v[60:63], v[152:155], 0
    v_mov_b32_dpp v211, v172 quad_perm:[0,0,0,0] row_mask:0xf bank_mask:0xf
    s_nop 1
    v_add_f32_dpp v211, v173, v211 quad_perm:[1,1,1,1] row_mask:0xf bank_mask:0xf
    s_nop 1
    v_add_f32_dpp v211, v174, v211 quad_perm:[2,2,2,2] row_mask:0xf bank_mask:0xf
    s_nop 1
    v_add_f32_dpp v211, v175, v211 quad_perm:[3,3,3,3] row_mask:0xf bank_mask:0xf
    v_mfma_f32_16x16x32_bf16 v[168:171], v[64:67], v[152:155], 0
    v_mov_b32_dpp v212, v160 quad_perm:[0,0,0,0] row_mask:0xf bank_mask:0xf
    s_nop 1
    v_add_f32_dpp v212, v161, v212 quad_perm:[1,1,1,1] row_mask:0xf bank_mask:0xf
    s_nop 1
    v_add_f32_dpp v212, v162, v212 quad_perm:[2,2,2,2] row_mask:0xf bank_mask:0xf
    s_nop 1
    v_add_f32_dpp v212, v163, v212 quad_perm:[3,3,3,3] row_mask:0xf bank_mask:0xf
    v_mfma_f32_16x16x32_bf16 v[172:175], v[68:71], v[152:155], 0
    v_mov_b32_dpp v213, v164 quad_perm:[0,0,0,0] row_mask:0xf bank_mask:0xf
    s_nop 1
    v_add_f32_dpp v213, v165, v213 quad_perm:[1,1,1,1] row_mask:0xf bank_mask:0xf
    s_nop 1
    v_add_f32_dpp v213, v166, v213 quad_perm:[2,2,2,2] row_mask:0xf bank_mask:0xf
    s_nop 1
    v_add_f32_dpp v213, v167, v213 quad_perm:[3,3,3,3] row_mask:0xf bank_mask:0xf
    v_mov_b32_dpp v214, v168 quad_perm:[0,0,0,0] row_mask:0xf bank_mask:0xf
    s_nop 1
    v_add_f32_dpp v214, v169, v214 quad_perm:[1,1,1,1] row_mask:0xf bank_mask:0xf
    s_nop 1
    v_add_f32_dpp v214, v170, v214 quad_perm:[2,2,2,2] row_mask:0xf bank_mask:0xf
    s_nop 1
    v_add_f32_dpp v214, v171, v214 quad_perm:[3,3,3,3] row_mask:0xf bank_mask:0xf
    v_mov_b32_dpp v215, v172 quad_perm:[0,0,0,0] row_mask:0xf bank_mask:0xf
    s_nop 1
    v_add_f32_dpp v215, v173, v215 quad_perm:[1,1,1,1] row_mask:0xf bank_mask:0xf
    s_nop 1
    v_add_f32_dpp v215, v174, v215 quad_perm:[2,2,2,2] row_mask:0xf bank_mask:0xf
    s_nop 1
    v_add_f32_dpp v215, v175, v215 quad_perm:[3,3,3,3] row_mask:0xf bank_mask:0xf
    v_max3_f32 v2, v200, v201, v202
    v_max3_f32 v2, v2, v203, v204
    v_max3_f32 v2, v2, v205, v206
    v_max3_f32 v2, v2, v207, v208
    v_max3_f32 v2, v2, v209, v210
    v_max3_f32 v2, v2, v211, v212
    v_max3_f32 v2, v2, v213, v214
    v_max_f32 v2, v2, v215
    v_mov_b32 v3, v2
    s_nop 1
    v_permlane16_swap_b32 v2, v3
    v_max_f32 v2, v2, v3
    v_mov_b32 v3, v2
    s_nop 1
    v_permlane32_swap_b32 v2, v3
    v_max_f32 v2, v2, v3
    s_mov_b32 s81, 0x3e0293ee
    v_mul_f32 v216, s81, v2
    v_fma_f32 v200, v200, s81, -v216
    v_fma_f32 v201, v201, s81, -v216
    v_fma_f32 v202, v202, s81, -v216
    v_fma_f32 v203, v203, s81, -v216
    v_fma_f32 v204, v204, s81, -v216
    v_fma_f32 v205, v205, s81, -v216
    v_fma_f32 v206, v206, s81, -v216
    v_fma_f32 v207, v207, s81, -v216
    v_fma_f32 v208, v208, s81, -v216
    v_fma_f32 v209, v209, s81, -v216
    v_fma_f32 v210, v210, s81, -v216
    v_fma_f32 v211, v211, s81, -v216
    v_fma_f32 v212, v212, s81, -v216
    v_fma_f32 v213, v213, s81, -v216
    v_fma_f32 v214, v214, s81, -v216
    v_fma_f32 v215, v215, s81, -v216
    v_exp_f32 v200, v200
    v_exp_f32 v201, v201
    v_exp_f32 v202, v202
    v_exp_f32 v203, v203
    v_exp_f32 v204, v204
    v_exp_f32 v205, v205
    v_exp_f32 v206, v206
    v_exp_f32 v207, v207
    v_exp_f32 v208, v208
    v_exp_f32 v209, v209
    v_exp_f32 v210, v210
    v_exp_f32 v211, v211
    v_exp_f32 v212, v212
    v_exp_f32 v213, v213
    v_exp_f32 v214, v214
    v_exp_f32 v215, v215
    v_add_f32 v217, v200, v201
    v_add_f32 v217, v217, v202
    v_add_f32 v217, v217, v203
    v_add_f32 v217, v217, v204
    v_add_f32 v217, v217, v205
    v_add_f32 v217, v217, v206
    v_add_f32 v217, v217, v207
    v_add_f32 v217, v217, v208
    v_add_f32 v217, v217, v209
    v_add_f32 v217, v217, v210
    v_add_f32 v217, v217, v211
    v_add_f32 v217, v217, v212
    v_add_f32 v217, v217, v213
    v_add_f32 v217, v217, v214
    v_add_f32 v217, v217, v215
    v_mov_b32 v3, v217
    s_nop 1
    v_permlane16_swap_b32 v217, v3
    v_add_f32 v217, v217, v3
    v_mov_b32 v3, v217
    s_nop 1
    v_permlane32_swap_b32 v217, v3
    v_add_f32 v217, v217, v3
    v_bfe_u32 v142, v1, 2, 2
    v_lshlrev_b32 v2, 6, v142
    s_lshl_b32 s82, s3, 3
    v_add_u32 v3, s82, v2
    ds_write_b64 v3, v[216:217] offset:38144
    s_waitcnt lgkmcnt(0)
    s_barrier
    ds_read_b128 v[160:163], v2 offset:38144
    ds_read_b128 v[164:167], v2 offset:38160
    ds_read_b128 v[168:171], v2 offset:38176
    ds_read_b128 v[172:175], v2 offset:38192
    s_waitcnt lgkmcnt(0)
    v_max3_f32 v218, v160, v162, v164
    v_max3_f32 v218, v218, v166, v168
    v_max3_f32 v218, v218, v170, v172
    v_max_f32 v218, v218, v174
    v_sub_f32 v160, v160, v218
    v_sub_f32 v162, v162, v218
    v_sub_f32 v164, v164, v218
    v_sub_f32 v166, v166, v218
    v_sub_f32 v168, v168, v218
    v_sub_f32 v170, v170, v218
    v_sub_f32 v172, v172, v218
    v_sub_f32 v174, v174, v218
    v_exp_f32 v160, v160
    v_exp_f32 v162, v162
    v_exp_f32 v164, v164
    v_exp_f32 v166, v166
    v_exp_f32 v168, v168
    v_exp_f32 v170, v170
    v_exp_f32 v172, v172
    v_exp_f32 v174, v174
    v_mul_f32 v219, v160, v161
    v_fmac_f32 v219, v162, v163
    v_fmac_f32 v219, v164, v165
    v_fmac_f32 v219, v166, v167
    v_fmac_f32 v219, v168, v169
    v_fmac_f32 v219, v170, v171
    v_fmac_f32 v219, v172, v173
    v_fmac_f32 v219, v174, v175
    v_sub_f32 v216, v216, v218
    v_exp_f32 v216, v216
    v_rcp_f32 v217, v219
    v_log_f32 v219, v219
    v_mul_f32 v216, v216, v217
    v_add_f32 v219, v219, v218
    v_lshlrev_b32 v142, 2, v142
    ds_write_b32 v142, v219 offset:38400
    v_mul_f32 v200, v200, v216
    v_mul_f32 v201, v201, v216
    v_mul_f32 v202, v202, v216
    v_mul_f32 v203, v203, v216
    v_mul_f32 v204, v204, v216
    v_mul_f32 v205, v205, v216
    v_mul_f32 v206, v206, v216
    v_mul_f32 v207, v207, v216
    v_mul_f32 v208, v208, v216
    v_mul_f32 v209, v209, v216
    v_mul_f32 v210, v210, v216
    v_mul_f32 v211, v211, v216
    v_mul_f32 v212, v212, v216
    v_mul_f32 v213, v213, v216
    v_mul_f32 v214, v214, v216
    v_mul_f32 v215, v215, v216
    v_cvt_pk_bf16_f32 v220, v200, v201
    v_cvt_pk_bf16_f32 v221, v202, v203
    v_cvt_pk_bf16_f32 v222, v204, v205
    v_cvt_pk_bf16_f32 v223, v206, v207
    v_cvt_pk_bf16_f32 v224, v208, v209
    v_cvt_pk_bf16_f32 v225, v210, v211
    v_cvt_pk_bf16_f32 v226, v212, v213
    v_cvt_pk_bf16_f32 v227, v214, v215
    s_lshl_b32 s82, s3, 11
    v_lshl_add_u32 v228, v1, 5, s82
    v_lshlrev_b32 v229, 4, v0
    v_lshrrev_b32 v2, 5, v0
    v_and_b32 v3, 31, v1
    v_lshlrev_b32 v230, 13, v2
    v_lshl_add_u32 v230, v3, 4, v230
    v_lshlrev_b32 v231, 2, v2
    s_lshl_b32 s82, s7, 15
    s_lshl_b32 s83, s4, 9
    s_add_u32 s82, s82, s83
    s_add_u32 s82, s82, 2162688
    v_lshrrev_b32 v2, 5, v1
    v_lshlrev_b32 v232, 2, v2
    v_lshl_add_u32 v232, v3, 3, v232
    s_mul_i32 s83, s3, 272
    v_add_u32 v232, s83, v232
    v_lshlrev_b32 v235, 31, v2
    v_xor_b32 v235, 1.0, v235
    v_mul_u32_u24 v233, 272, v4
    v_lshl_add_u32 v233, v5, 4, v233
    v_bfe_u32 v2, v1, 2, 2
    v_lshl_add_u32 v3, v5, 3, v2
    v_lshlrev_b32 v234, 8, v3
    v_lshlrev_b32 v2, 1, v2
    v_and_b32 v3, 8, v3
    v_or_b32 v2, v2, v3
    v_bfe_u32 v3, v1, 1, 1
    s_lshl_b32 s83, s3, 1
    v_add_u32 v3, s83, v3
    v_xor_b32 v2, v2, v3
    v_lshl_add_u32 v234, v2, 4, v234
    v_and_b32 v2, 1, v1
    v_lshl_add_u32 v234, v2, 3, v234
    v_add_u32 v234, 90112, v234
    v_mul_u32_u24 v236, 0x3000, v5
    v_lshl_add_u32 v236, v4, 4, v236
    s_lshl_b32 s83, s89, 3
    s_add_u32 s83, s83, s3
    s_mul_i32 s83, s83, 0xc000
    s_lshl_b32 s84, s88, 7
    s_add_u32 s83, s83, s84
    s_add_u32 s83, s83, 2629632
    s_lshl_b32 s80, s88, 13
    s_lshl_b32 s81, s3, 10
    s_add_u32 s80, s80, s81
    s_add_u32 s80, s80, 2162688
    v_mov_b32 v139, s5
    s_waitcnt vmcnt(18)
    v_perm_b32 v8, v76, v72, s98
    v_perm_b32 v12, v76, v72, s99
    v_perm_b32 v16, v77, v73, s98
    v_perm_b32 v20, v77, v73, s99
    v_perm_b32 v24, v78, v74, s98
    v_perm_b32 v28, v78, v74, s99
    v_perm_b32 v32, v79, v75, s98
    v_perm_b32 v36, v79, v75, s99
    s_waitcnt vmcnt(16)
    v_perm_b32 v9, v84, v80, s98
    v_perm_b32 v13, v84, v80, s99
    v_perm_b32 v17, v85, v81, s98
    v_perm_b32 v21, v85, v81, s99
    v_perm_b32 v25, v86, v82, s98
    v_perm_b32 v29, v86, v82, s99
    v_perm_b32 v33, v87, v83, s98
    v_perm_b32 v37, v87, v83, s99
    s_waitcnt vmcnt(14)
    v_perm_b32 v10, v92, v88, s98
    v_perm_b32 v14, v92, v88, s99
    v_perm_b32 v18, v93, v89, s98
    v_perm_b32 v22, v93, v89, s99
    v_perm_b32 v26, v94, v90, s98
    v_perm_b32 v30, v94, v90, s99
    v_perm_b32 v34, v95, v91, s98
    v_perm_b32 v38, v95, v91, s99
    s_waitcnt vmcnt(12)
    v_perm_b32 v11, v100, v96, s98
    v_perm_b32 v15, v100, v96, s99
    s_nop 0
    v_mfma_f32_16x16x32_bf16 v[160:163], v[220:223], v[8:11], 0
    v_perm_b32 v19, v101, v97, s98
    v_mfma_f32_16x16x32_bf16 v[164:167], v[220:223], v[12:15], 0
    v_perm_b32 v23, v101, v97, s99
    v_mfma_f32_16x16x32_bf16 v[168:171], v[220:223], v[16:19], 0
    v_perm_b32 v27, v102, v98, s98
    v_mfma_f32_16x16x32_bf16 v[172:175], v[220:223], v[20:23], 0
    v_perm_b32 v31, v102, v98, s99
    v_mfma_f32_16x16x32_bf16 v[176:179], v[220:223], v[24:27], 0
    v_perm_b32 v35, v103, v99, s98
    v_mfma_f32_16x16x32_bf16 v[180:183], v[220:223], v[28:31], 0
    v_perm_b32 v39, v103, v99, s99
    v_mfma_f32_16x16x32_bf16 v[184:187], v[220:223], v[32:35], 0
    s_nop 0
    v_mfma_f32_16x16x32_bf16 v[188:191], v[220:223], v[36:39], 0
    s_waitcnt vmcnt(10)
    v_perm_b32 v40, v108, v104, s98
    v_perm_b32 v44, v108, v104, s99
    v_perm_b32 v48, v109, v105, s98
    v_perm_b32 v52, v109, v105, s99
    v_perm_b32 v56, v110, v106, s98
    v_perm_b32 v60, v110, v106, s99
    v_perm_b32 v64, v111, v107, s98
    v_perm_b32 v68, v111, v107, s99
    s_waitcnt vmcnt(8)
    v_perm_b32 v41, v116, v112, s98
    v_perm_b32 v45, v116, v112, s99
    v_perm_b32 v49, v117, v113, s98
    v_perm_b32 v53, v117, v113, s99
    v_perm_b32 v57, v118, v114, s98
    v_perm_b32 v61, v118, v114, s99
    v_perm_b32 v65, v119, v115, s98
    v_perm_b32 v69, v119, v115, s99
    s_waitcnt vmcnt(6)
    v_perm_b32 v42, v124, v120, s98
    v_perm_b32 v46, v124, v120, s99
    v_perm_b32 v50, v125, v121, s98
    v_perm_b32 v54, v125, v121, s99
    v_perm_b32 v58, v126, v122, s98
    v_perm_b32 v62, v126, v122, s99
    v_perm_b32 v66, v127, v123, s98
    v_perm_b32 v70, v127, v123, s99
    s_waitcnt vmcnt(4)
    v_perm_b32 v43, v132, v128, s98
    v_perm_b32 v47, v132, v128, s99
    s_nop 0
    v_mfma_f32_16x16x32_bf16 v[160:163], v[224:227], v[40:43], v[160:163]
    v_perm_b32 v51, v133, v129, s98
    v_mfma_f32_16x16x32_bf16 v[164:167], v[224:227], v[44:47], v[164:167]
    v_perm_b32 v55, v133, v129, s99
    v_mfma_f32_16x16x32_bf16 v[168:171], v[224:227], v[48:51], v[168:171]
    v_perm_b32 v59, v134, v130, s98
    v_mfma_f32_16x16x32_bf16 v[172:175], v[224:227], v[52:55], v[172:175]
    v_perm_b32 v63, v134, v130, s99
    v_mfma_f32_16x16x32_bf16 v[176:179], v[224:227], v[56:59], v[176:179]
    v_perm_b32 v67, v135, v131, s98
    v_mfma_f32_16x16x32_bf16 v[180:183], v[224:227], v[60:63], v[180:183]
    v_perm_b32 v71, v135, v131, s99
    v_mfma_f32_16x16x32_bf16 v[184:187], v[224:227], v[64:67], v[184:187]
    s_nop 0
    v_mfma_f32_16x16x32_bf16 v[188:191], v[224:227], v[68:71], v[188:191]
    v_mov_b32 v161, v164
    v_mov_b32 v162, v168
    v_mov_b32 v163, v172
    ds_write_b128 v228, v[160:163] offset:40960
    v_mov_b32 v177, v180
    s_nop 0
    v_mov_b32 v178, v184
    s_nop 0
    v_mov_b32 v179, v188
    ds_write_b128 v228, v[176:179] offset:40976
    s_waitcnt lgkmcnt(0)
    s_barrier
    s_cmp_ge_u32 s3, 2
    s_cbranch_scc1 L_B_s5
    ds_read_b128 v[160:163], v229 offset:40960
    ds_read_b128 v[164:167], v229 offset:43008
    ds_read_b128 v[168:171], v229 offset:45056
    ds_read_b128 v[172:175], v229 offset:47104
    ds_read_b128 v[176:179], v229 offset:49152
    ds_read_b128 v[180:183], v229 offset:51200
    ds_read_b128 v[184:187], v229 offset:53248
    ds_read_b128 v[188:191], v229 offset:55296
    ds_read_b32 v138, v231 offset:38400
    s_waitcnt lgkmcnt(7)
    v_pk_add_f32 v[160:161], v[160:161], v[164:165]
    v_pk_add_f32 v[162:163], v[162:163], v[166:167]
    s_waitcnt lgkmcnt(6)
    v_pk_add_f32 v[160:161], v[160:161], v[168:169]
    v_pk_add_f32 v[162:163], v[162:163], v[170:171]
    s_waitcnt lgkmcnt(5)
    v_pk_add_f32 v[160:161], v[160:161], v[172:173]
    v_pk_add_f32 v[162:163], v[162:163], v[174:175]
    s_waitcnt lgkmcnt(4)
    v_pk_add_f32 v[160:161], v[160:161], v[176:177]
    v_pk_add_f32 v[162:163], v[162:163], v[178:179]
    s_waitcnt lgkmcnt(3)
    v_pk_add_f32 v[160:161], v[160:161], v[180:181]
    v_pk_add_f32 v[162:163], v[162:163], v[182:183]
    s_waitcnt lgkmcnt(2)
    v_pk_add_f32 v[160:161], v[160:161], v[184:185]
    v_pk_add_f32 v[162:163], v[162:163], v[186:187]
    s_waitcnt lgkmcnt(1)
    v_pk_add_f32 v[160:161], v[160:161], v[188:189]
    v_pk_add_f32 v[162:163], v[162:163], v[190:191]
    v_cvt_pk_bf16_f32 v136, v160, v161
    v_cvt_pk_bf16_f32 v137, v162, v163
    s_waitcnt lgkmcnt(0)
    s_cmp_eq_u32 s95, 1
    s_cbranch_scc0 L_rem_6
    buffer_store_dwordx4 v[136:139], v230, s[8:11], s82 offen
    s_branch L_std_7
L_rem_6:
    s_nop 7
    buffer_store_dwordx4 v[136:139], v230, s[8:11], s82 offen sc1
L_std_7:
L_B_s5:
    buffer_load_dwordx4 v[64:67], v7, s[8:11], s80 offen sc1
    s_waitcnt vmcnt(0)
L_poll_8:
    s_mov_b64 s[0:1], exec
    v_cmpx_eq_u32 vcc, s5, v67
    s_andn2_b64 exec, s[0:1], exec
    s_cbranch_scc0 L_got_9
    buffer_load_dwordx4 v[64:67], v7, s[8:11], s80 offen sc1
    s_sub_u32 s6, s6, 1
    s_cmp_gt_i32 s6, 0
    s_waitcnt vmcnt(0)
    s_cbranch_scc1 L_poll_8
L_got_9:
    s_mov_b64 exec, -1
    s_nop 3
    v_mov_b32 v3, v66
    v_lshlrev_b32 v68, 16, v64
    v_and_b32 v69, 0xffff0000, v64
    v_permlane32_swap_b32 v66, v3
    v_sub_f32 v2, v3, v66
    v_mul_f32 v2, v2, v235
    v_exp_f32 v2, v2
    v_lshlrev_b32 v70, 16, v65
    v_add_f32 v2, 1.0, v2
    v_rcp_f32 v2, v2
    v_and_b32 v71, 0xffff0000, v65
    v_pk_mul_f32 v[68:69], v[68:69], v[2:3] op_sel_hi:[1,0]
    v_pk_mul_f32 v[70:71], v[70:71], v[2:3] op_sel_hi:[1,0]
    s_nop 1
    v_permlane32_swap_b32 v68, v70
    v_permlane32_swap_b32 v69, v71
    v_pk_add_f32 v[68:69], v[68:69], v[70:71]
    v_cvt_pk_bf16_f32 v68, v68, v69
    ds_write_b32 v232, v68 offset:38656
    s_waitcnt lgkmcnt(0)
    s_barrier
    ds_read_b128 v[24:27], v233 offset:38656
    ds_read_b64_tr_b16 v[8:9], v234 offset:0
    ds_read_b64_tr_b16 v[10:11], v234 offset:1024
    ds_read_b128 v[28:31], v233 offset:38720
    ds_read_b64_tr_b16 v[12:13], v234 offset:8192
    ds_read_b64_tr_b16 v[14:15], v234 offset:9216
    ds_read_b128 v[32:35], v233 offset:38784
    ds_read_b64_tr_b16 v[16:17], v234 offset:16384
    ds_read_b64_tr_b16 v[18:19], v234 offset:17408
    ds_read_b128 v[36:39], v233 offset:38848
    ds_read_b64_tr_b16 v[20:21], v234 offset:24576
    ds_read_b64_tr_b16 v[22:23], v234 offset:25600
    s_waitcnt lgkmcnt(9)
    v_mfma_f32_16x16x32_bf16 v[40:43], v[8:11], v[24:27], 0
    s_waitcnt lgkmcnt(6)
    v_mfma_f32_16x16x32_bf16 v[40:43], v[12:15], v[28:31], v[40:43]
    s_waitcnt lgkmcnt(3)
    v_mfma_f32_16x16x32_bf16 v[40:43], v[16:19], v[32:35], v[40:43]
    s_waitcnt lgkmcnt(0)
    v_mfma_f32_16x16x32_bf16 v[40:43], v[20:23], v[36:39], v[40:43]
    s_nop 7
    v_perm_b32 v136, v40, v43, s92
    v_perm_b32 v137, v41, v43, s93
    v_perm_b32 v138, v42, v43, s94
    s_mov_b64 exec, s[96:97]
    buffer_store_dwordx4 v[136:139], v236, s[8:11], s83 offen sc1
    s_mov_b64 exec, -1
    s_branch L_S6
L_A:
    s_and_b32 s29, s3, 3
    v_lshlrev_b32 v249, 4, v6
    v_add_u32 v249, 147456, v249
    s_cmp_ge_u32 s3, 4
    s_cbranch_scc1 L_A_qk
    s_lshl_b32 s86, s7, 22
    s_lshl_b32 s79, s4, 18
    s_add_u32 s86, s86, s79
    s_lshl_b32 s79, s3, 14
    s_add_u32 s86, s86, s79
    s_lshl_b32 m0, s79, 1
    v_xor_b32 v136, 0, v7
    v_xor_b32 v137, 32, v7
    v_xor_b32 v138, 64, v7
    v_xor_b32 v139, 96, v7
    v_xor_b32 v140, 128, v7
    v_xor_b32 v141, 160, v7
    v_xor_b32 v142, 192, v7
    v_xor_b32 v143, 224, v7
    v_xor_b32 v144, 16, v7
    v_xor_b32 v145, 48, v7
    v_xor_b32 v146, 80, v7
    v_xor_b32 v147, 112, v7
    v_xor_b32 v148, 144, v7
    v_xor_b32 v149, 176, v7
    v_xor_b32 v150, 208, v7
    v_xor_b32 v151, 240, v7
    s_waitcnt lgkmcnt(0)
    s_mov_b64 s[12:13], s[50:51]
    s_mov_b32 s14, 0x2000000
    s_mov_b32 s15, 0x00020000
    buffer_load_dwordx4 v136, s[12:15], s86 offen offset:0 nt lds
    buffer_load_dwordx4 v137, s[12:15], s86 offen offset:1024 nt lds
    buffer_load_dwordx4 v138, s[12:15], s86 offen offset:2048 nt lds
    buffer_load_dwordx4 v139, s[12:15], s86 offen offset:3072 nt lds
    s_add_u32 s86, s86, 4096
    s_add_u32 m0, m0, 4096
    s_add_u32 s76, s76, 0xffffff
    s_addc_u32 s77, s77, 0
    s_and_b32 s76, s76, 0xff000000
    s_load_dword s5, s[76:77], 0
    s_mov_b64 s[8:9], s[76:77]
    s_mov_b32 s10, 0xa00000
    s_mov_b32 s11, 0x00020000
    s_mov_b64 s[40:41], s[72:73]
    s_mov_b32 s42, 0x2000
    s_mov_b32 s43, 0x00020000
    s_mov_b64 s[16:17], s[56:57]
    s_mov_b32 s18, 0x400000
    s_mov_b32 s19, 0x00020000
    s_mov_b64 s[20:21], s[58:59]
    s_mov_b32 s22, 0x400000
    s_mov_b32 s23, 0x00020000
    v_lshrrev_b32 v2, 2, v1
    v_and_b32 v3, 7, v2
    v_lshlrev_b32 v3, 1, v3
    v_lshrrev_b32 v224, 5, v1
    v_or_b32 v3, v3, v224
    v_bfe_u32 v224, v1, 1, 1
    s_lshl_b32 s80, s3, 4
    v_add_u32 v224, s80, v224
    v_xor_b32 v3, v3, v224
    v_lshlrev_b32 v2, 10, v2
    v_and_b32 v224, 1, v1
    v_lshl_add_u32 v2, v224, 3, v2
    v_lshl_add_u32 v224, v3, 4, v2
    v_xor_b32 v225, 32, v224
    v_xor_b32 v226, 64, v224
    v_xor_b32 v227, 96, v224
    v_xor_b32 v228, 128, v224
    v_xor_b32 v229, 160, v224
    v_xor_b32 v230, 192, v224
    v_xor_b32 v231, 224, v224
    v_add_u32 v232, 0x10000, v224
    v_add_u32 v233, 0x10000, v225
    v_add_u32 v234, 0x10000, v226
    v_add_u32 v235, 0x10000, v227
    v_add_u32 v236, 0x10000, v228
    v_add_u32 v237, 0x10000, v229
    v_add_u32 v238, 0x10000, v230
    v_add_u32 v239, 0x10000, v231
    v_add_u32 v252, 131072, v7
    v_lshrrev_b32 v2, 1, v6
    v_mul_u32_u24 v248, 49152, v2
    v_and_b32 v2, 1, v1
    v_lshl_add_u32 v3, v5, 1, v2
    v_lshl_add_u32 v248, v3, 4, v248
    buffer_load_dwordx4 v140, s[12:15], s86 offen offset:0 nt lds
    buffer_load_dwordx4 v141, s[12:15], s86 offen offset:1024 nt lds
    buffer_load_dwordx4 v142, s[12:15], s86 offen offset:2048 nt lds
    buffer_load_dwordx4 v143, s[12:15], s86 offen offset:3072 nt lds
    s_add_u32 s86, s86, 4096
    s_add_u32 m0, m0, 4096
    s_waitcnt vmcnt(7)
    buffer_load_dwordx4 v144, s[12:15], s86 offen offset:0 nt lds
    s_waitcnt vmcnt(7)
    buffer_load_dwordx4 v145, s[12:15], s86 offen offset:1024 nt lds
    s_waitcnt vmcnt(7)
    buffer_load_dwordx4 v146, s[12:15], s86 offen offset:2048 nt lds
    s_waitcnt vmcnt(7)
    buffer_load_dwordx4 v147, s[12:15], s86 offen offset:3072 nt lds
    s_add_u32 s86, s86, 4096
    s_add_u32 m0, m0, 4096
    s_waitcnt vmcnt(7)
    buffer_load_dwordx4 v148, s[12:15], s86 offen offset:0 nt lds
    s_waitcnt vmcnt(7)
    buffer_load_dwordx4 v149, s[12:15], s86 offen offset:1024 nt lds
    s_waitcnt vmcnt(7)
    buffer_load_dwordx4 v150, s[12:15], s86 offen offset:2048 nt lds
    s_waitcnt vmcnt(7)
    buffer_load_dwordx4 v151, s[12:15], s86 offen offset:3072 nt lds
    s_add_u32 s86, s86, 53248
    s_add_u32 m0, m0, 4096
    s_waitcnt vmcnt(7)
    buffer_load_dwordx4 v136, s[12:15], s86 offen offset:0 nt lds
    s_waitcnt vmcnt(7)
    buffer_load_dwordx4 v137, s[12:15], s86 offen offset:1024 nt lds
    s_waitcnt vmcnt(7)
    buffer_load_dwordx4 v138, s[12:15], s86 offen offset:2048 nt lds
    s_waitcnt vmcnt(7)
    buffer_load_dwordx4 v139, s[12:15], s86 offen offset:3072 nt lds
    s_add_u32 s86, s86, 4096
    s_add_u32 m0, m0, 4096
    s_waitcnt vmcnt(7)
    buffer_load_dwordx4 v140, s[12:15], s86 offen offset:0 nt lds
    s_waitcnt vmcnt(7)
    buffer_load_dwordx4 v141, s[12:15], s86 offen offset:1024 nt lds
    s_waitcnt vmcnt(7)
    buffer_load_dwordx4 v142, s[12:15], s86 offen offset:2048 nt lds
    s_waitcnt vmcnt(7)
    s_barrier
    ds_read_b64_tr_b16 v[8:9], v224 offset:0
    ds_read_b64_tr_b16 v[12:13], v225 offset:0
    ds_read_b64_tr_b16 v[16:17], v226 offset:0
    ds_read_b64_tr_b16 v[20:21], v227 offset:0
    ds_read_b64_tr_b16 v[24:25], v224 offset:32768
    ds_read_b64_tr_b16 v[28:29], v225 offset:32768
    ds_read_b64_tr_b16 v[32:33], v226 offset:32768
    ds_read_b64_tr_b16 v[36:37], v227 offset:32768
    ds_read_b64_tr_b16 v[40:41], v232 offset:0
    ds_read_b64_tr_b16 v[44:45], v233 offset:0
    ds_read_b64_tr_b16 v[48:49], v234 offset:0
    ds_read_b64_tr_b16 v[52:53], v235 offset:0
    ds_read_b64_tr_b16 v[56:57], v232 offset:32768
    ds_read_b64_tr_b16 v[60:61], v233 offset:32768
    ds_read_b64_tr_b16 v[64:65], v234 offset:32768
    ds_read_b64_tr_b16 v[68:69], v235 offset:32768
    ds_read_b64_tr_b16 v[72:73], v228 offset:0
    ds_read_b64_tr_b16 v[76:77], v229 offset:0
    ds_read_b64_tr_b16 v[80:81], v230 offset:0
    ds_read_b64_tr_b16 v[84:85], v231 offset:0
    ds_read_b64_tr_b16 v[88:89], v228 offset:32768
    ds_read_b64_tr_b16 v[92:93], v229 offset:32768
    ds_read_b64_tr_b16 v[96:97], v230 offset:32768
    ds_read_b64_tr_b16 v[100:101], v231 offset:32768
    ds_read_b64_tr_b16 v[104:105], v236 offset:0
    ds_read_b64_tr_b16 v[108:109], v237 offset:0
    ds_read_b64_tr_b16 v[112:113], v238 offset:0
    ds_read_b64_tr_b16 v[116:117], v239 offset:0
    ds_read_b64_tr_b16 v[120:121], v236 offset:32768
    ds_read_b64_tr_b16 v[124:125], v237 offset:32768
    ds_read_b64_tr_b16 v[128:129], v238 offset:32768
    ds_read_b64_tr_b16 v[132:133], v239 offset:32768
    s_waitcnt vmcnt(7)
    buffer_load_dwordx4 v143, s[12:15], s86 offen offset:3072 nt lds
    s_add_u32 s86, s86, 4096
    s_add_u32 m0, m0, 4096
    s_waitcnt vmcnt(7)
    buffer_load_dwordx4 v144, s[12:15], s86 offen offset:0 nt lds
    s_waitcnt vmcnt(7)
    buffer_load_dwordx4 v145, s[12:15], s86 offen offset:1024 nt lds
    s_waitcnt vmcnt(7)
    buffer_load_dwordx4 v146, s[12:15], s86 offen offset:2048 nt lds
    s_waitcnt vmcnt(7)
    buffer_load_dwordx4 v147, s[12:15], s86 offen offset:3072 nt lds
    s_add_u32 s86, s86, 4096
    s_add_u32 m0, m0, 4096
    s_waitcnt vmcnt(7)
    buffer_load_dwordx4 v148, s[12:15], s86 offen offset:0 nt lds
    s_waitcnt vmcnt(7)
    buffer_load_dwordx4 v149, s[12:15], s86 offen offset:1024 nt lds
    s_waitcnt vmcnt(7)
    buffer_load_dwordx4 v150, s[12:15], s86 offen offset:2048 nt lds
    s_waitcnt vmcnt(7)
    buffer_load_dwordx4 v151, s[12:15], s86 offen offset:3072 nt lds
    s_add_u32 s86, s86, 53248
    s_sub_u32 m0, m0, 28672
    s_waitcnt lgkmcnt(0)
    s_add_u32 s5, s5, 0x9e3779b9
    s_add_u32 s95, s95, s5
    s_barrier
    s_waitcnt vmcnt(7)
    buffer_load_dwordx4 v136, s[12:15], s86 offen offset:0 nt lds
    s_waitcnt vmcnt(7)
    buffer_load_dwordx4 v137, s[12:15], s86 offen offset:1024 nt lds
    s_waitcnt vmcnt(7)
    buffer_load_dwordx4 v138, s[12:15], s86 offen offset:2048 nt lds
    s_waitcnt vmcnt(7)
    buffer_load_dwordx4 v139, s[12:15], s86 offen offset:3072 nt lds
    s_add_u32 s86, s86, 4096
    s_add_u32 m0, m0, 4096
    s_waitcnt vmcnt(7)
    buffer_load_dwordx4 v140, s[12:15], s86 offen offset:0 nt lds
    s_waitcnt vmcnt(7)
    buffer_load_dwordx4 v141, s[12:15], s86 offen offset:1024 nt lds
    s_waitcnt vmcnt(7)
    buffer_load_dwordx4 v142, s[12:15], s86 offen offset:2048 nt lds
    s_waitcnt vmcnt(7)
    s_barrier
    ds_read_b64_tr_b16 v[10:11], v224 offset:16384
    ds_read_b64_tr_b16 v[14:15], v225 offset:16384
    ds_read_b64_tr_b16 v[18:19], v226 offset:16384
    ds_read_b64_tr_b16 v[22:23], v227 offset:16384
    ds_read_b64_tr_b16 v[26:27], v224 offset:49152
    ds_read_b64_tr_b16 v[30:31], v225 offset:49152
    ds_read_b64_tr_b16 v[34:35], v226 offset:49152
    ds_read_b64_tr_b16 v[38:39], v227 offset:49152
    ds_read_b64_tr_b16 v[42:43], v232 offset:16384
    ds_read_b64_tr_b16 v[46:47], v233 offset:16384
    ds_read_b64_tr_b16 v[50:51], v234 offset:16384
    ds_read_b64_tr_b16 v[54:55], v235 offset:16384
    ds_read_b64_tr_b16 v[58:59], v232 offset:49152
    ds_read_b64_tr_b16 v[62:63], v233 offset:49152
    ds_read_b64_tr_b16 v[66:67], v234 offset:49152
    ds_read_b64_tr_b16 v[70:71], v235 offset:49152
    ds_read_b64_tr_b16 v[74:75], v228 offset:16384
    ds_read_b64_tr_b16 v[78:79], v229 offset:16384
    ds_read_b64_tr_b16 v[82:83], v230 offset:16384
    ds_read_b64_tr_b16 v[86:87], v231 offset:16384
    ds_read_b64_tr_b16 v[90:91], v228 offset:49152
    ds_read_b64_tr_b16 v[94:95], v229 offset:49152
    ds_read_b64_tr_b16 v[98:99], v230 offset:49152
    ds_read_b64_tr_b16 v[102:103], v231 offset:49152
    ds_read_b64_tr_b16 v[106:107], v236 offset:16384
    ds_read_b64_tr_b16 v[110:111], v237 offset:16384
    ds_read_b64_tr_b16 v[114:115], v238 offset:16384
    ds_read_b64_tr_b16 v[118:119], v239 offset:16384
    ds_read_b64_tr_b16 v[122:123], v236 offset:49152
    ds_read_b64_tr_b16 v[126:127], v237 offset:49152
    ds_read_b64_tr_b16 v[130:131], v238 offset:49152
    ds_read_b64_tr_b16 v[134:135], v239 offset:49152
    s_waitcnt vmcnt(7)
    buffer_load_dwordx4 v143, s[12:15], s86 offen offset:3072 nt lds
    s_add_u32 s86, s86, 4096
    s_add_u32 m0, m0, 4096
    s_waitcnt vmcnt(7)
    buffer_load_dwordx4 v144, s[12:15], s86 offen offset:0 nt lds
    s_waitcnt vmcnt(7)
    buffer_load_dwordx4 v145, s[12:15], s86 offen offset:1024 nt lds
    s_waitcnt vmcnt(7)
    buffer_load_dwordx4 v146, s[12:15], s86 offen offset:2048 nt lds
    s_waitcnt lgkmcnt(0)
    s_barrier
    s_waitcnt vmcnt(7)
    buffer_load_dwordx4 v147, s[12:15], s86 offen offset:3072 nt lds
    s_add_u32 s86, s86, 4096
    s_add_u32 m0, m0, 4096
    s_waitcnt vmcnt(7)
    buffer_load_dwordx4 v148, s[12:15], s86 offen offset:0 nt lds
    s_waitcnt vmcnt(7)
    buffer_load_dwordx4 v149, s[12:15], s86 offen offset:1024 nt lds
    s_waitcnt vmcnt(7)
    buffer_load_dwordx4 v150, s[12:15], s86 offen offset:2048 nt lds
    s_waitcnt vmcnt(7)
    buffer_load_dwordx4 v151, s[12:15], s86 offen offset:3072 nt lds
    s_add_u32 s86, s86, 53248
    s_add_u32 m0, m0, 4096
    s_waitcnt vmcnt(7)
    buffer_load_dwordx4 v136, s[12:15], s86 offen offset:0 nt lds
    s_waitcnt vmcnt(7)
    buffer_load_dwordx4 v137, s[12:15], s86 offen offset:1024 nt lds
    s_waitcnt vmcnt(7)
    buffer_load_dwordx4 v138, s[12:15], s86 offen offset:2048 nt lds
    s_waitcnt vmcnt(7)
    buffer_load_dwordx4 v139, s[12:15], s86 offen offset:3072 nt lds
    s_add_u32 s86, s86, 4096
    s_add_u32 m0, m0, 4096
    s_waitcnt vmcnt(7)
    buffer_load_dwordx4 v140, s[12:15], s86 offen offset:0 nt lds
    s_waitcnt vmcnt(7)
    buffer_load_dwordx4 v141, s[12:15], s86 offen offset:1024 nt lds
    s_waitcnt vmcnt(7)
    buffer_load_dwordx4 v142, s[12:15], s86 offen offset:2048 nt lds
    s_waitcnt vmcnt(7)
    buffer_load_dwordx4 v143, s[12:15], s86 offen offset:3072 nt lds
    s_add_u32 s86, s86, 4096
    s_add_u32 m0, m0, 4096
    s_waitcnt vmcnt(7)
    buffer_load_dwordx4 v144, s[12:15], s86 offen offset:0 nt lds
    s_waitcnt vmcnt(7)
    buffer_load_dwordx4 v145, s[12:15], s86 offen offset:1024 nt lds
    s_waitcnt vmcnt(7)
    buffer_load_dwordx4 v146, s[12:15], s86 offen offset:2048 nt lds
    s_waitcnt vmcnt(7)
    buffer_load_dwordx4 v147, s[12:15], s86 offen offset:3072 nt lds
    s_add_u32 s86, s86, 4096
    s_add_u32 m0, m0, 4096
    s_waitcnt vmcnt(7)
    buffer_load_dwordx4 v148, s[12:15], s86 offen offset:0 nt lds
    s_waitcnt vmcnt(7)
    buffer_load_dwordx4 v149, s[12:15], s86 offen offset:1024 nt lds
    s_waitcnt vmcnt(7)
    buffer_load_dwordx4 v150, s[12:15], s86 offen offset:2048 nt lds
    s_waitcnt vmcnt(7)
    buffer_load_dwordx4 v151, s[12:15], s86 offen offset:3072 nt lds
    s_lshl_b32 s78, s7, 7
    s_bfe_u32 s79, s2, 0x10003
    s_lshl_b32 s79, s79, 11
    s_add_u32 s78, s78, s79
    s_add_u32 s78, s78, 4096
    v_lshlrev_b32 v254, 2, v6
    buffer_load_dword v254, v254, s[8:11], s78 offen sc1
    s_mul_i32 s80, s7, 786432
    s_add_u32 s80, s80, 4194304
    s_lshl_b32 s81, s3, 7
    s_add_u32 s82, s80, s81
    s_mul_i32 s83, s4, 49152
    s_add_u32 s82, s82, s83
    s_add_u32 s83, s82, 24576
    s_mul_i32 s84, s4, 3072
    s_add_u32 s80, s80, s84
    s_lshl1_add_u32 s80, s81, s80
    s_add_u32 s81, s80, 393216
    v_and_b32 v2, 1, v1
    v_lshrrev_b32 v3, 3, v1
    v_mul_u32_u24 v240, 3072, v3
    v_lshl_add_u32 v240, v4, 4, v240
    v_lshlrev_b32 v241, 14, v2
    v_bfe_u32 v2, v1, 1, 2
    v_lshl_add_u32 v2, v5, 2, v2
    v_lshl_add_u32 v241, v2, 4, v241
    s_lshl_b32 s84, s4, 15
    s_lshl_b32 s85, s7, 11
    s_add_u32 s84, s84, s85
    s_lshl_b32 s85, s3, 8
    s_add_u32 s84, s84, s85
    s_add_u32 s84, s84, 1638400
    v_lshlrev_b32 v2, 7, v5
    v_lshl_add_u32 v2, v4, 4, v2
    v_lshrrev_b32 v3, 3, v6
    v_lshl_add_u32 v2, v3, 11, v2
    v_add_u32 v242, 151552, v2
    v_lshl_add_u32 v3, v3, 2, v5
    v_mul_u32_u24 v243, 0x3000, v3
    v_lshl_add_u32 v243, v4, 4, v243
    s_and_b32 s86, s4, 1
    s_lshl3_add_u32 s86, s86, s3
    s_mul_i32 s86, s86, 0x18000
    s_lshl_b32 s87, s7, 10
    s_add_u32 s86, s86, s87
    s_lshr_b32 s87, s4, 1
    s_lshl_b32 s87, s87, 7
    s_add_u32 s86, s86, s87
    s_add_u32 s86, s86, 2621440
    v_bfe_u32 v2, v1, 2, 3
    v_lshlrev_b32 v2, 1, v2
    v_bfe_u32 v3, v1, 1, 1
    s_lshl_b32 s87, s3, 2
    v_add_u32 v244, s87, v3
    v_xor_b32 v2, v2, v244
    v_lshrrev_b32 v244, 2, v1
    v_lshlrev_b32 v244, 9, v244
    v_lshl_add_u32 v244, v2, 4, v244
    v_and_b32 v2, 1, v1
    v_lshl_add_u32 v244, v2, 3, v244
    v_add_u32 v244, 16384, v244
    v_xor_b32 v246, 32, v244
    v_add_u32 v245, 0x10000, v244
    v_add_u32 v247, 0x10000, v246
    s_waitcnt vmcnt(1)
    s_barrier
    ds_read_b64_tr_b16 v[136:137], v224 offset:0
    ds_read_b64_tr_b16 v[138:139], v224 offset:16384
    ds_read_b64_tr_b16 v[140:141], v225 offset:0
    ds_read_b64_tr_b16 v[142:143], v225 offset:16384
    ds_read_b64_tr_b16 v[144:145], v226 offset:0
    ds_read_b64_tr_b16 v[146:147], v226 offset:16384
    ds_read_b64_tr_b16 v[148:149], v227 offset:0
    ds_read_b64_tr_b16 v[150:151], v227 offset:16384
    ds_read_b64_tr_b16 v[152:153], v224 offset:32768
    ds_read_b64_tr_b16 v[154:155], v224 offset:49152
    ds_read_b64_tr_b16 v[156:157], v225 offset:32768
    ds_read_b64_tr_b16 v[158:159], v225 offset:49152
    ds_read_b64_tr_b16 v[160:161], v226 offset:32768
    ds_read_b64_tr_b16 v[162:163], v226 offset:49152
    ds_read_b64_tr_b16 v[164:165], v227 offset:32768
    ds_read_b64_tr_b16 v[166:167], v227 offset:49152
    s_barrier
    s_barrier
    ds_read_b128 v[168:171], v249 offset:0
    ds_read_b128 v[172:175], v249 offset:256
    s_waitcnt lgkmcnt(0)
    v_max3_f32 v250, v168, v169, v170
    v_max_f32 v250, v250, v171
    v_max3_f32 v251, v172, v173, v174
    v_max_f32 v251, v251, v175
    s_waitcnt vmcnt(0)
    v_cmp_eq_u32 vcc, s95, v254
    s_nop 1
    s_cmp_eq_u64 vcc, -1
    s_cselect_b32 s95, 1, 0
    s_cmp_eq_u32 s95, 1
    s_barrier
    ds_read_b128 v[200:203], v252 offset:0
    ds_read_b128 v[204:207], v252 offset:1024
    ds_read_b128 v[208:211], v252 offset:2048
    ds_read_b128 v[212:215], v252 offset:3072
    ds_read_b128 v[216:219], v252 offset:4096
    ds_read_b128 v[220:223], v252 offset:5120
    s_waitcnt lgkmcnt(5)
    v_mfma_f32_16x16x32_bf16 v[168:171], v[8:11], v[200:203], 0
    v_mfma_f32_16x16x32_bf16 v[172:175], v[12:15], v[200:203], 0
    v_mfma_f32_16x16x32_bf16 v[176:179], v[16:19], v[200:203], 0
    v_mfma_f32_16x16x32_bf16 v[180:183], v[20:23], v[200:203], 0
    s_waitcnt lgkmcnt(4)
    v_mfma_f32_16x16x32_bf16 v[184:187], v[8:11], v[204:207], 0
    v_mfma_f32_16x16x32_bf16 v[188:191], v[12:15], v[204:207], 0
    v_mfma_f32_16x16x32_bf16 v[192:195], v[16:19], v[204:207], 0
    v_mfma_f32_16x16x32_bf16 v[196:199], v[20:23], v[204:207], 0
    ds_read_b128 v[200:203], v252 offset:6144
    ds_read_b128 v[204:207], v252 offset:7168
    ds_read_b64_tr_b16 v[8:9], v232 offset:0
    ds_read_b64_tr_b16 v[10:11], v232 offset:16384
    ds_read_b64_tr_b16 v[12:13], v233 offset:0
    ds_read_b64_tr_b16 v[14:15], v233 offset:16384
    ds_read_b64_tr_b16 v[16:17], v234 offset:0
    ds_read_b64_tr_b16 v[18:19], v234 offset:16384
    ds_read_b64_tr_b16 v[20:21], v235 offset:0
    ds_read_b64_tr_b16 v[22:23], v235 offset:16384
    s_waitcnt lgkmcnt(13)
    v_mfma_f32_16x16x32_bf16 v[168:171], v[24:27], v[208:211], v[168:171]
    v_mfma_f32_16x16x32_bf16 v[172:175], v[28:31], v[208:211], v[172:175]
    v_mfma_f32_16x16x32_bf16 v[176:179], v[32:35], v[208:211], v[176:179]
    v_mfma_f32_16x16x32_bf16 v[180:183], v[36:39], v[208:211], v[180:183]
    s_waitcnt lgkmcnt(12)
    v_mfma_f32_16x16x32_bf16 v[184:187], v[24:27], v[212:215], v[184:187]
    v_mfma_f32_16x16x32_bf16 v[188:191], v[28:31], v[212:215], v[188:191]
    v_mfma_f32_16x16x32_bf16 v[192:195], v[32:35], v[212:215], v[192:195]
    v_mfma_f32_16x16x32_bf16 v[196:199], v[36:39], v[212:215], v[196:199]
    ds_read_b128 v[208:211], v252 offset:0
    ds_read_b128 v[212:215], v252 offset:1024
    ds_read_b64_tr_b16 v[24:25], v232 offset:32768
    ds_read_b64_tr_b16 v[26:27], v232 offset:49152
    ds_read_b64_tr_b16 v[28:29], v233 offset:32768
    ds_read_b64_tr_b16 v[30:31], v233 offset:49152
    ds_read_b64_tr_b16 v[32:33], v234 offset:32768
    ds_read_b64_tr_b16 v[34:35], v234 offset:49152
    ds_read_b64_tr_b16 v[36:37], v235 offset:32768
    ds_read_b64_tr_b16 v[38:39], v235 offset:49152
    s_waitcnt lgkmcnt(15)
    v_mfma_f32_16x16x32_bf16 v[168:171], v[40:43], v[216:219], v[168:171]
    v_mfma_f32_16x16x32_bf16 v[172:175], v[44:47], v[216:219], v[172:175]
    v_mfma_f32_16x16x32_bf16 v[176:179], v[48:51], v[216:219], v[176:179]
    v_mfma_f32_16x16x32_bf16 v[180:183], v[52:55], v[216:219], v[180:183]
    s_waitcnt lgkmcnt(15)
    v_mfma_f32_16x16x32_bf16 v[184:187], v[40:43], v[220:223], v[184:187]
    v_mfma_f32_16x16x32_bf16 v[188:191], v[44:47], v[220:223], v[188:191]
    v_mfma_f32_16x16x32_bf16 v[192:195], v[48:51], v[220:223], v[192:195]
    v_mfma_f32_16x16x32_bf16 v[196:199], v[52:55], v[220:223], v[196:199]
    ds_read_b128 v[216:219], v252 offset:2048
    ds_read_b128 v[220:223], v252 offset:3072
    s_waitcnt lgkmcnt(15)
    v_mfma_f32_16x16x32_bf16 v[168:171], v[56:59], v[200:203], v[168:171]
    v_mfma_f32_16x16x32_bf16 v[172:175], v[60:63], v[200:203], v[172:175]
    v_mfma_f32_16x16x32_bf16 v[176:179], v[64:67], v[200:203], v[176:179]
    v_mfma_f32_16x16x32_bf16 v[180:183], v[68:71], v[200:203], v[180:183]
    s_waitcnt lgkmcnt(15)
    v_mfma_f32_16x16x32_bf16 v[184:187], v[56:59], v[204:207], v[184:187]
    v_mfma_f32_16x16x32_bf16 v[188:191], v[60:63], v[204:207], v[188:191]
    v_mfma_f32_16x16x32_bf16 v[192:195], v[64:67], v[204:207], v[192:195]
    v_mfma_f32_16x16x32_bf16 v[196:199], v[68:71], v[204:207], v[196:199]
    s_barrier
    ds_read_b128 v[200:203], v252 offset:8192
    ds_read_b128 v[204:207], v252 offset:9216
    s_waitcnt lgkmcnt(13)
    v_mfma_f32_16x16x32_bf16 v[40:43], v[72:75], v[208:211], 0
    v_mfma_f32_16x16x32_bf16 v[44:47], v[76:79], v[208:211], 0
    v_mfma_f32_16x16x32_bf16 v[48:51], v[80:83], v[208:211], 0
    v_mfma_f32_16x16x32_bf16 v[52:55], v[84:87], v[208:211], 0
    s_waitcnt lgkmcnt(12)
    v_mfma_f32_16x16x32_bf16 v[56:59], v[72:75], v[212:215], 0
    v_mfma_f32_16x16x32_bf16 v[60:63], v[76:79], v[212:215], 0
    v_mfma_f32_16x16x32_bf16 v[64:67], v[80:83], v[212:215], 0
    v_mfma_f32_16x16x32_bf16 v[68:71], v[84:87], v[212:215], 0
    ds_read_b128 v[208:211], v252 offset:10240
    ds_read_b128 v[212:215], v252 offset:11264
    s_waitcnt lgkmcnt(5)
    v_mfma_f32_16x16x32_bf16 v[40:43], v[88:91], v[216:219], v[40:43]
    v_mfma_f32_16x16x32_bf16 v[44:47], v[92:95], v[216:219], v[44:47]
    v_mfma_f32_16x16x32_bf16 v[48:51], v[96:99], v[216:219], v[48:51]
    v_mfma_f32_16x16x32_bf16 v[52:55], v[100:103], v[216:219], v[52:55]
    s_waitcnt lgkmcnt(4)
    v_mfma_f32_16x16x32_bf16 v[56:59], v[88:91], v[220:223], v[56:59]
    v_mfma_f32_16x16x32_bf16 v[60:63], v[92:95], v[220:223], v[60:63]
    v_mfma_f32_16x16x32_bf16 v[64:67], v[96:99], v[220:223], v[64:67]
    v_mfma_f32_16x16x32_bf16 v[68:71], v[100:103], v[220:223], v[68:71]
    ds_read_b128 v[216:219], v252 offset:12288
    ds_read_b128 v[220:223], v252 offset:13312
    s_waitcnt lgkmcnt(15)
    s_waitcnt lgkmcnt(5)
    v_mfma_f32_16x16x32_bf16 v[168:171], v[136:139], v[200:203], v[168:171]
    v_mfma_f32_16x16x32_bf16 v[172:175], v[140:143], v[200:203], v[172:175]
    v_mfma_f32_16x16x32_bf16 v[176:179], v[144:147], v[200:203], v[176:179]
    v_mfma_f32_16x16x32_bf16 v[180:183], v[148:151], v[200:203], v[180:183]
    s_waitcnt lgkmcnt(4)
    v_mfma_f32_16x16x32_bf16 v[184:187], v[136:139], v[204:207], v[184:187]
    v_mfma_f32_16x16x32_bf16 v[188:191], v[140:143], v[204:207], v[188:191]
    v_mfma_f32_16x16x32_bf16 v[192:195], v[144:147], v[204:207], v[192:195]
    v_mfma_f32_16x16x32_bf16 v[196:199], v[148:151], v[204:207], v[196:199]
    ds_read_b128 v[200:203], v252 offset:14336
    ds_read_b128 v[204:207], v252 offset:15360
    ds_read_b64_tr_b16 v[136:137], v228 offset:0
    ds_read_b64_tr_b16 v[138:139], v228 offset:16384
    ds_read_b64_tr_b16 v[140:141], v229 offset:0
    ds_read_b64_tr_b16 v[142:143], v229 offset:16384
    ds_read_b64_tr_b16 v[144:145], v230 offset:0
    ds_read_b64_tr_b16 v[146:147], v230 offset:16384
    ds_read_b64_tr_b16 v[148:149], v231 offset:0
    ds_read_b64_tr_b16 v[150:151], v231 offset:16384
    s_waitcnt lgkmcnt(15)
    s_waitcnt lgkmcnt(13)
    v_mfma_f32_16x16x32_bf16 v[168:171], v[152:155], v[208:211], v[168:171]
    v_mfma_f32_16x16x32_bf16 v[172:175], v[156:159], v[208:211], v[172:175]
    v_mfma_f32_16x16x32_bf16 v[176:179], v[160:163], v[208:211], v[176:179]
    v_mfma_f32_16x16x32_bf16 v[180:183], v[164:167], v[208:211], v[180:183]
    s_waitcnt lgkmcnt(12)
    v_mfma_f32_16x16x32_bf16 v[184:187], v[152:155], v[212:215], v[184:187]
    v_mfma_f32_16x16x32_bf16 v[188:191], v[156:159], v[212:215], v[188:191]
    v_mfma_f32_16x16x32_bf16 v[192:195], v[160:163], v[212:215], v[192:195]
    v_mfma_f32_16x16x32_bf16 v[196:199], v[164:167], v[212:215], v[196:199]
    ds_read_b128 v[208:211], v252 offset:4096
    ds_read_b128 v[212:215], v252 offset:5120
    s_barrier
    ds_read_b128 v[72:75], v249 offset:512
    ds_read_b128 v[76:79], v249 offset:768
    ds_read_b64_tr_b16 v[152:153], v228 offset:32768
    ds_read_b64_tr_b16 v[154:155], v228 offset:49152
    ds_read_b64_tr_b16 v[156:157], v229 offset:32768
    ds_read_b64_tr_b16 v[158:159], v229 offset:49152
    ds_read_b64_tr_b16 v[160:161], v230 offset:32768
    ds_read_b64_tr_b16 v[162:163], v230 offset:49152
    ds_read_b64_tr_b16 v[164:165], v231 offset:32768
    ds_read_b64_tr_b16 v[166:167], v231 offset:49152
    s_waitcnt lgkmcnt(15)
    s_waitcnt lgkmcnt(15)
    v_mfma_f32_16x16x32_bf16 v[168:171], v[8:11], v[216:219], v[168:171]
    v_mfma_f32_16x16x32_bf16 v[172:175], v[12:15], v[216:219], v[172:175]
    v_mfma_f32_16x16x32_bf16 v[176:179], v[16:19], v[216:219], v[176:179]
    v_mfma_f32_16x16x32_bf16 v[180:183], v[20:23], v[216:219], v[180:183]
    s_waitcnt lgkmcnt(15)
    v_mfma_f32_16x16x32_bf16 v[184:187], v[8:11], v[220:223], v[184:187]
    v_mfma_f32_16x16x32_bf16 v[188:191], v[12:15], v[220:223], v[188:191]
    v_mfma_f32_16x16x32_bf16 v[192:195], v[16:19], v[220:223], v[192:195]
    v_mfma_f32_16x16x32_bf16 v[196:199], v[20:23], v[220:223], v[196:199]
    ds_read_b128 v[216:219], v252 offset:6144
    ds_read_b128 v[220:223], v252 offset:7168
    ds_read_b64_tr_b16 v[8:9], v236 offset:0
    ds_read_b64_tr_b16 v[10:11], v236 offset:16384
    ds_read_b64_tr_b16 v[12:13], v237 offset:0
    ds_read_b64_tr_b16 v[14:15], v237 offset:16384
    ds_read_b64_tr_b16 v[16:17], v238 offset:0
    ds_read_b64_tr_b16 v[18:19], v238 offset:16384
    ds_read_b64_tr_b16 v[20:21], v239 offset:0
    ds_read_b64_tr_b16 v[22:23], v239 offset:16384
    s_waitcnt lgkmcnt(15)
    s_waitcnt lgkmcnt(15)
    s_waitcnt lgkmcnt(15)
    v_mfma_f32_16x16x32_bf16 v[168:171], v[24:27], v[200:203], v[168:171]
    v_add_f32 v72, v72, v73
    v_add_f32 v76, v76, v77
    v_mfma_f32_16x16x32_bf16 v[172:175], v[28:31], v[200:203], v[172:175]
    v_add_f32 v74, v74, v75
    v_add_f32 v78, v78, v79
    v_mfma_f32_16x16x32_bf16 v[176:179], v[32:35], v[200:203], v[176:179]
    v_add_f32_dpp v250, v72, v74 quad_perm:[0,1,2,3] row_mask:0xa bank_mask:0xf
    v_add_f32_dpp v251, v76, v78 quad_perm:[0,1,2,3] row_mask:0xa bank_mask:0xf
    v_mfma_f32_16x16x32_bf16 v[180:183], v[36:39], v[200:203], v[180:183]
    s_waitcnt lgkmcnt(15)
    v_mfma_f32_16x16x32_bf16 v[184:187], v[24:27], v[204:207], v[184:187]
    v_mfma_f32_16x16x32_bf16 v[188:191], v[28:31], v[204:207], v[188:191]
    v_mfma_f32_16x16x32_bf16 v[192:195], v[32:35], v[204:207], v[192:195]
    v_mfma_f32_16x16x32_bf16 v[196:199], v[36:39], v[204:207], v[196:199]
    ds_read_b128 v[200:203], v252 offset:8192
    ds_read_b128 v[204:207], v252 offset:9216
    ds_read_b64_tr_b16 v[24:25], v236 offset:32768
    ds_read_b64_tr_b16 v[26:27], v236 offset:49152
    ds_read_b64_tr_b16 v[28:29], v237 offset:32768
    ds_read_b64_tr_b16 v[30:31], v237 offset:49152
    ds_read_b64_tr_b16 v[32:33], v238 offset:32768
    ds_read_b64_tr_b16 v[34:35], v238 offset:49152
    ds_read_b64_tr_b16 v[36:37], v239 offset:32768
    ds_read_b64_tr_b16 v[38:39], v239 offset:49152
    s_waitcnt lgkmcnt(15)
    v_mfma_f32_16x16x32_bf16 v[40:43], v[104:107], v[208:211], v[40:43]
    v_mfma_f32_16x16x32_bf16 v[44:47], v[108:111], v[208:211], v[44:47]
    v_mfma_f32_16x16x32_bf16 v[48:51], v[112:115], v[208:211], v[48:51]
    v_mfma_f32_16x16x32_bf16 v[52:55], v[116:119], v[208:211], v[52:55]
    s_waitcnt lgkmcnt(15)
    v_mfma_f32_16x16x32_bf16 v[56:59], v[104:107], v[212:215], v[56:59]
    v_cvt_pk_bf16_f32 v168, v168, v169
    v_cvt_pk_bf16_f32 v169, v170, v171
    v_mfma_f32_16x16x32_bf16 v[60:63], v[108:111], v[212:215], v[60:63]
    v_cvt_pk_bf16_f32 v170, v172, v173
    v_mov_b32 v171, s5
    v_mfma_f32_16x16x32_bf16 v[64:67], v[112:115], v[212:215], v[64:67]
    s_cbranch_scc1 L_ps_10
    buffer_store_dwordx4 v[168:171], v248, s[8:11], s80 offen offset:0 sc1
    s_branch L_ps_11
L_ps_10:
    buffer_store_dwordx4 v[168:171], v248, s[8:11], s80 offen offset:0
L_ps_11:
    v_cvt_pk_bf16_f32 v172, v174, v175
    v_mfma_f32_16x16x32_bf16 v[68:71], v[116:119], v[212:215], v[68:71]
    v_cvt_pk_bf16_f32 v173, v176, v177
    v_cvt_pk_bf16_f32 v174, v178, v179
    ds_read_b128 v[208:211], v252 offset:10240
    ds_read_b128 v[212:215], v252 offset:11264
    s_waitcnt lgkmcnt(15)
    v_mfma_f32_16x16x32_bf16 v[40:43], v[120:123], v[216:219], v[40:43]
    v_mov_b32 v175, s5
    s_cbranch_scc1 L_ps_12
    buffer_store_dwordx4 v[172:175], v248, s[8:11], s80 offen offset:1024 sc1
    s_branch L_ps_13
L_ps_12:
    buffer_store_dwordx4 v[172:175], v248, s[8:11], s80 offen offset:1024
L_ps_13:
    v_mfma_f32_16x16x32_bf16 v[44:47], v[124:127], v[216:219], v[44:47]
    v_cvt_pk_bf16_f32 v176, v180, v181
    v_cvt_pk_bf16_f32 v177, v182, v183
    v_mfma_f32_16x16x32_bf16 v[48:51], v[128:131], v[216:219], v[48:51]
    v_mov_b32 v178, v250
    v_mov_b32 v179, s5
    v_mfma_f32_16x16x32_bf16 v[52:55], v[132:135], v[216:219], v[52:55]
    s_cbranch_scc1 L_ps_14
    buffer_store_dwordx4 v[176:179], v248, s[8:11], s80 offen offset:2048 sc1
    s_branch L_ps_15
L_ps_14:
    buffer_store_dwordx4 v[176:179], v248, s[8:11], s80 offen offset:2048
L_ps_15:
    v_cvt_pk_bf16_f32 v184, v184, v185
    s_waitcnt lgkmcnt(15)
    v_mfma_f32_16x16x32_bf16 v[56:59], v[120:123], v[220:223], v[56:59]
    v_cvt_pk_bf16_f32 v185, v186, v187
    v_cvt_pk_bf16_f32 v186, v188, v189
    v_mfma_f32_16x16x32_bf16 v[60:63], v[124:127], v[220:223], v[60:63]
    v_mov_b32 v187, s5
    s_cbranch_scc1 L_ps_16
    buffer_store_dwordx4 v[184:187], v248, s[8:11], s81 offen offset:0 sc1
    s_branch L_ps_17
L_ps_16:
    buffer_store_dwordx4 v[184:187], v248, s[8:11], s81 offen offset:0
L_ps_17:
    v_mfma_f32_16x16x32_bf16 v[64:67], v[128:131], v[220:223], v[64:67]
    v_cvt_pk_bf16_f32 v188, v190, v191
    v_cvt_pk_bf16_f32 v189, v192, v193
    v_mfma_f32_16x16x32_bf16 v[68:71], v[132:135], v[220:223], v[68:71]
    v_cvt_pk_bf16_f32 v190, v194, v195
    v_mov_b32 v191, s5
    ds_read_b128 v[216:219], v252 offset:12288
    ds_read_b128 v[220:223], v252 offset:13312
    s_waitcnt lgkmcnt(15)
    s_waitcnt lgkmcnt(13)
    v_mfma_f32_16x16x32_bf16 v[40:43], v[136:139], v[200:203], v[40:43]
    s_cbranch_scc1 L_ps_18
    buffer_store_dwordx4 v[188:191], v248, s[8:11], s81 offen offset:1024 sc1
    s_branch L_ps_19
L_ps_18:
    buffer_store_dwordx4 v[188:191], v248, s[8:11], s81 offen offset:1024
L_ps_19:
    v_cvt_pk_bf16_f32 v192, v196, v197
    v_mfma_f32_16x16x32_bf16 v[44:47], v[140:143], v[200:203], v[44:47]
    v_cvt_pk_bf16_f32 v193, v198, v199
    v_mov_b32 v194, v251
    v_mfma_f32_16x16x32_bf16 v[48:51], v[144:147], v[200:203], v[48:51]
    v_mov_b32 v195, s5
    s_cbranch_scc1 L_ps_20
    buffer_store_dwordx4 v[192:195], v248, s[8:11], s81 offen offset:2048 sc1
    s_branch L_ps_21
L_ps_20:
    buffer_store_dwordx4 v[192:195], v248, s[8:11], s81 offen offset:2048
L_ps_21:
    v_mfma_f32_16x16x32_bf16 v[52:55], v[148:151], v[200:203], v[52:55]
    s_waitcnt lgkmcnt(12)
    v_mfma_f32_16x16x32_bf16 v[56:59], v[136:139], v[204:207], v[56:59]
    v_mfma_f32_16x16x32_bf16 v[60:63], v[140:143], v[204:207], v[60:63]
    v_mfma_f32_16x16x32_bf16 v[64:67], v[144:147], v[204:207], v[64:67]
    v_mfma_f32_16x16x32_bf16 v[68:71], v[148:151], v[204:207], v[68:71]
    ds_read_b128 v[200:203], v252 offset:14336
    ds_read_b128 v[204:207], v252 offset:15360
    s_waitcnt lgkmcnt(15)
    s_waitcnt lgkmcnt(5)
    v_mfma_f32_16x16x32_bf16 v[40:43], v[152:155], v[208:211], v[40:43]
    v_mfma_f32_16x16x32_bf16 v[44:47], v[156:159], v[208:211], v[44:47]
    v_mfma_f32_16x16x32_bf16 v[48:51], v[160:163], v[208:211], v[48:51]
    v_mfma_f32_16x16x32_bf16 v[52:55], v[164:167], v[208:211], v[52:55]
    s_waitcnt lgkmcnt(4)
    v_mfma_f32_16x16x32_bf16 v[56:59], v[152:155], v[212:215], v[56:59]
    v_mfma_f32_16x16x32_bf16 v[60:63], v[156:159], v[212:215], v[60:63]
    v_mfma_f32_16x16x32_bf16 v[64:67], v[160:163], v[212:215], v[64:67]
    v_mfma_f32_16x16x32_bf16 v[68:71], v[164:167], v[212:215], v[68:71]
    s_waitcnt lgkmcnt(15)
    s_waitcnt lgkmcnt(3)
    v_mfma_f32_16x16x32_bf16 v[40:43], v[8:11], v[216:219], v[40:43]
    v_mfma_f32_16x16x32_bf16 v[44:47], v[12:15], v[216:219], v[44:47]
    v_mfma_f32_16x16x32_bf16 v[48:51], v[16:19], v[216:219], v[48:51]
    v_mfma_f32_16x16x32_bf16 v[52:55], v[20:23], v[216:219], v[52:55]
    s_waitcnt lgkmcnt(2)
    v_mfma_f32_16x16x32_bf16 v[56:59], v[8:11], v[220:223], v[56:59]
    v_mfma_f32_16x16x32_bf16 v[60:63], v[12:15], v[220:223], v[60:63]
    v_mfma_f32_16x16x32_bf16 v[64:67], v[16:19], v[220:223], v[64:67]
    v_mfma_f32_16x16x32_bf16 v[68:71], v[20:23], v[220:223], v[68:71]
    s_waitcnt lgkmcnt(6)
    s_waitcnt lgkmcnt(1)
    v_mfma_f32_16x16x32_bf16 v[40:43], v[24:27], v[200:203], v[40:43]
    v_mfma_f32_16x16x32_bf16 v[44:47], v[28:31], v[200:203], v[44:47]
    v_mfma_f32_16x16x32_bf16 v[48:51], v[32:35], v[200:203], v[48:51]
    v_mfma_f32_16x16x32_bf16 v[52:55], v[36:39], v[200:203], v[52:55]
    s_waitcnt lgkmcnt(0)
    v_mfma_f32_16x16x32_bf16 v[56:59], v[24:27], v[204:207], v[56:59]
    v_mfma_f32_16x16x32_bf16 v[60:63], v[28:31], v[204:207], v[60:63]
    v_mfma_f32_16x16x32_bf16 v[64:67], v[32:35], v[204:207], v[64:67]
    v_mfma_f32_16x16x32_bf16 v[68:71], v[36:39], v[204:207], v[68:71]
    v_cvt_pk_bf16_f32 v40, v40, v41
    v_cvt_pk_bf16_f32 v41, v42, v43
    v_cvt_pk_bf16_f32 v42, v44, v45
    v_mov_b32 v43, s5
    s_cbranch_scc1 L_ps_22
    buffer_store_dwordx4 v[40:43], v248, s[8:11], s80 offen offset:128 sc1
    s_branch L_ps_23
L_ps_22:
    buffer_store_dwordx4 v[40:43], v248, s[8:11], s80 offen offset:128
L_ps_23:
    v_cvt_pk_bf16_f32 v44, v46, v47
    v_cvt_pk_bf16_f32 v45, v48, v49
    v_cvt_pk_bf16_f32 v46, v50, v51
    v_mov_b32 v47, s5
    s_cbranch_scc1 L_ps_24
    buffer_store_dwordx4 v[44:47], v248, s[8:11], s80 offen offset:1152 sc1
    s_branch L_ps_25
L_ps_24:
    buffer_store_dwordx4 v[44:47], v248, s[8:11], s80 offen offset:1152
L_ps_25:
    v_cvt_pk_bf16_f32 v48, v52, v53
    v_cvt_pk_bf16_f32 v49, v54, v55
    v_mov_b32 v50, v250
    v_mov_b32 v51, s5
    s_cbranch_scc1 L_ps_26
    buffer_store_dwordx4 v[48:51], v248, s[8:11], s80 offen offset:2176 sc1
    s_branch L_ps_27
L_ps_26:
    buffer_store_dwordx4 v[48:51], v248, s[8:11], s80 offen offset:2176
L_ps_27:
    v_cvt_pk_bf16_f32 v56, v56, v57
    v_cvt_pk_bf16_f32 v57, v58, v59
    v_cvt_pk_bf16_f32 v58, v60, v61
    v_mov_b32 v59, s5
    s_cbranch_scc1 L_ps_28
    buffer_store_dwordx4 v[56:59], v248, s[8:11], s81 offen offset:128 sc1
    s_branch L_ps_29
L_ps_28:
    buffer_store_dwordx4 v[56:59], v248, s[8:11], s81 offen offset:128
L_ps_29:
    v_cvt_pk_bf16_f32 v60, v62, v63
    v_cvt_pk_bf16_f32 v61, v64, v65
    v_cvt_pk_bf16_f32 v62, v66, v67
    v_mov_b32 v63, s5
    s_cbranch_scc1 L_ps_30
    buffer_store_dwordx4 v[60:63], v248, s[8:11], s81 offen offset:1152 sc1
    s_branch L_ps_31
L_ps_30:
    buffer_store_dwordx4 v[60:63], v248, s[8:11], s81 offen offset:1152
L_ps_31:
    v_cvt_pk_bf16_f32 v64, v68, v69
    v_cvt_pk_bf16_f32 v65, v70, v71
    v_mov_b32 v66, v251
    v_mov_b32 v67, s5
    s_cbranch_scc1 L_ps_32
    buffer_store_dwordx4 v[64:67], v248, s[8:11], s81 offen offset:2176 sc1
    s_branch L_ps_33
L_ps_32:
    buffer_store_dwordx4 v[64:67], v248, s[8:11], s81 offen offset:2176
L_ps_33:
    v_mov_b32 v107, s5
    v_mov_b32 v111, s5
    v_lshrrev_b32 v2, 5, v1
    v_lshlrev_b32 v3, 1, v2
    v_xor_b32 v3, v3, v1
    v_and_b32 v3, 31, v3
    v_lshlrev_b32 v3, 4, v3
    v_lshl_add_u32 v138, v2, 10, v3
    v_xor_b32 v139, 64, v138
    v_xor_b32 v140, 128, v138
    v_xor_b32 v141, 192, v138
    s_lshl_b32 s31, s7, 19
    s_lshr_b32 s78, s4, 1
    s_lshl_b32 s78, s78, 16
    s_add_u32 s31, s31, s78
    s_lshl_b32 s78, s29, 14
    s_add_u32 s31, s31, s78
    s_lshl1_add_u32 m0, s78, 16384
    s_and_b32 s78, s4, 1
    s_lshl_b32 s78, s78, 9
    s_add_u32 s31, s31, s78
    s_barrier
    buffer_load_dwordx4 v[200:203], v240, s[8:11], s82 offen offset:0 sc1
    buffer_load_dwordx4 v[204:207], v240, s[8:11], s82 offen offset:1024 sc1
    buffer_load_dwordx4 v[208:211], v240, s[8:11], s82 offen offset:2048 sc1
    buffer_load_dwordx4 v[212:215], v240, s[8:11], s83 offen offset:0 sc1
    buffer_load_dwordx4 v[216:219], v240, s[8:11], s83 offen offset:1024 sc1
    buffer_load_dwordx4 v[220:223], v240, s[8:11], s83 offen offset:2048 sc1
    s_waitcnt vmcnt(0)
L_poll_34:
    s_mov_b64 s[0:1], exec
    v_cmpx_eq_u32 vcc, s5, v203
    v_cmpx_eq_u32 vcc, s5, v207
    v_cmpx_eq_u32 vcc, s5, v211
    v_cmpx_eq_u32 vcc, s5, v215
    v_cmpx_eq_u32 vcc, s5, v219
    v_cmpx_eq_u32 vcc, s5, v223
    s_andn2_b64 exec, s[0:1], exec
    s_cbranch_scc0 L_got_35
    buffer_load_dwordx4 v[200:203], v240, s[8:11], s82 offen offset:0 sc1
    buffer_load_dwordx4 v[204:207], v240, s[8:11], s82 offen offset:1024 sc1
    buffer_load_dwordx4 v[208:211], v240, s[8:11], s82 offen offset:2048 sc1
    buffer_load_dwordx4 v[212:215], v240, s[8:11], s83 offen offset:0 sc1
    buffer_load_dwordx4 v[216:219], v240, s[8:11], s83 offen offset:1024 sc1
    buffer_load_dwordx4 v[220:223], v240, s[8:11], s83 offen offset:2048 sc1
    s_sub_u32 s6, s6, 1
    s_cmp_gt_i32 s6, 0
    s_waitcnt vmcnt(0)
    s_cbranch_scc1 L_poll_34
L_got_35:
    s_mov_b64 exec, -1
    s_nop 3
    buffer_load_dwordx4 v138, s[20:23], s31 offen nt lds
    s_add_u32 s31, s31, 2048
    s_add_u32 m0, m0, 1024
    s_nop 0
    buffer_load_dwordx4 v139, s[20:23], s31 offen nt lds
    s_add_u32 s31, s31, 2048
    s_add_u32 m0, m0, 1024
    s_nop 0
    buffer_load_dwordx4 v140, s[20:23], s31 offen nt lds
    s_add_u32 s31, s31, 2048
    s_add_u32 m0, m0, 1024
    s_nop 0
    buffer_load_dwordx4 v141, s[20:23], s31 offen nt lds
    s_add_u32 s31, s31, 2048
    s_add_u32 m0, m0, 1024
    s_nop 0
    buffer_load_dwordx4 v138, s[20:23], s31 offen nt lds
    s_add_u32 s31, s31, 2048
    s_add_u32 m0, m0, 1024
    s_nop 0
    buffer_load_dwordx4 v139, s[20:23], s31 offen nt lds
    s_add_u32 s31, s31, 2048
    s_add_u32 m0, m0, 1024
    s_nop 0
    buffer_load_dwordx4 v140, s[20:23], s31 offen nt lds
    s_add_u32 s31, s31, 2048
    s_add_u32 m0, m0, 1024
    s_nop 0
    buffer_load_dwordx4 v141, s[20:23], s31 offen nt lds
    s_branch L_A_pg
L_A_qk:
    s_setprio 3
    s_lshl_b32 s80, s29, 15
    v_lshlrev_b32 v2, 1, v4
    v_lshrrev_b32 v3, 3, v6
    v_or_b32 v2, v2, v3
    v_lshlrev_b32 v2, 4, v2
    v_lshl_add_u32 v2, v6, 10, v2
    v_lshl_add_u32 v2, v5, 8, v2
    v_add_u32 v136, s80, v2
    v_add_u32 v232, 131072, v2
    s_waitcnt lgkmcnt(0)
    s_mov_b64 s[32:33], s[48:49]
    s_mov_b32 s34, 0x2000
    s_mov_b32 s35, 0x00020000
    s_mov_b64 s[36:37], s[70:71]
    s_mov_b32 s38, 0x400
    s_mov_b32 s39, 0x00020000
    s_cmp_lg_u32 s3, 7
    s_cbranch_scc1 L_A_ng
    s_bfe_u32 s78, s2, 0x10003
    s_lshl_b32 s78, s78, 12
    v_lshrrev_b32 v2, 2, v1
    v_lshlrev_b32 v2, 6, v2
    v_and_b32 v3, 3, v1
    v_lshl_add_u32 v3, v3, 10, v2
    buffer_load_dwordx4 v[152:155], v3, s[32:35], s78 offen offset:0
    buffer_load_dwordx4 v[156:159], v3, s[32:35], s78 offen offset:16
    buffer_load_dwordx4 v[160:163], v3, s[32:35], s78 offen offset:32
    buffer_load_dwordx4 v[164:167], v3, s[32:35], s78 offen offset:48
    buffer_load_dwordx4 v[168:171], v2, s[36:39], 0 offen offset:0
    buffer_load_dwordx4 v[172:175], v2, s[36:39], 0 offen offset:16
    buffer_load_dwordx4 v[176:179], v2, s[36:39], 0 offen offset:32
    buffer_load_dwordx4 v[180:183], v2, s[36:39], 0 offen offset:48
L_A_ng:
    s_add_u32 s76, s76, 0xffffff
    s_addc_u32 s77, s77, 0
    s_and_b32 s76, s76, 0xff000000
    s_load_dword s5, s[76:77], 0
    s_mov_b64 s[8:9], s[76:77]
    s_mov_b32 s10, 0xa00000
    s_mov_b32 s11, 0x00020000
    s_mov_b64 s[40:41], s[72:73]
    s_mov_b32 s42, 0x2000
    s_mov_b32 s43, 0x00020000
    s_mov_b64 s[16:17], s[56:57]
    s_mov_b32 s18, 0x400000
    s_mov_b32 s19, 0x00020000
    s_mov_b64 s[20:21], s[58:59]
    s_mov_b32 s22, 0x400000
    s_mov_b32 s23, 0x00020000
    s_cmp_lg_u32 s3, 4
    s_cbranch_scc1 L_W5
    s_lshr_b32 s78, s4, 1
    s_lshl3_add_u32 s78, s78, s7
    s_lshl_b32 s78, s78, 20
    s_add_u32 s78, s78, 786432
    s_load_dword s24, s[62:63], s78
    s_load_dword s25, s[64:65], s78
    s_branch L_W7
L_W5:
    s_cmp_lg_u32 s3, 5
    s_cbranch_scc1 L_W7
    s_and_b32 s78, s4, 1
    s_lshl_b32 s78, s78, 21
    s_lshl_b32 s79, s7, 19
    s_load_dword s24, s[66:67], s78
    s_load_dword s25, s[56:57], s78
    s_load_dword s26, s[58:59], s79
    s_load_dword s27, s[68:69], s79
    s_load_dword s28, s[72:73], 0
L_W7:
    v_xor_b32 v137, 16, v136
    v_xor_b32 v233, 16, v232
    v_xor_b32 v138, 32, v136
    v_xor_b32 v234, 32, v232
    v_xor_b32 v139, 48, v136
    v_xor_b32 v235, 48, v232
    v_xor_b32 v140, 64, v136
    v_xor_b32 v236, 64, v232
    v_xor_b32 v141, 80, v136
    v_xor_b32 v237, 80, v232
    v_xor_b32 v142, 96, v136
    v_xor_b32 v238, 96, v232
    v_xor_b32 v143, 112, v136
    v_xor_b32 v239, 112, v232
    v_xor_b32 v144, 128, v136
    v_xor_b32 v240, 128, v232
    v_xor_b32 v145, 144, v136
    v_xor_b32 v241, 144, v232
    v_xor_b32 v146, 160, v136
    v_xor_b32 v242, 160, v232
    v_xor_b32 v147, 176, v136
    v_xor_b32 v243, 176, v232
    v_xor_b32 v148, 192, v136
    v_xor_b32 v244, 192, v232
    v_xor_b32 v149, 208, v136
    v_xor_b32 v245, 208, v232
    v_xor_b32 v150, 224, v136
    v_xor_b32 v246, 224, v232
    v_xor_b32 v151, 240, v136
    v_xor_b32 v247, 240, v232
    v_lshrrev_b32 v2, 1, v1
    s_and_b32 s80, s29, 1
    v_xor_b32 v2, s80, v2
    v_lshlrev_b32 v2, 4, v2
    v_and_b32 v3, 1, v1
    v_lshl_add_u32 v2, v3, 3, v2
    s_lshl_b32 s81, s29, 13
    s_add_u32 s81, s81, 131072
    v_add_u32 v216, s81, v2
    v_xor_b32 v217, 32, v216
    v_xor_b32 v218, 64, v216
    v_xor_b32 v219, 96, v216
    v_xor_b32 v220, 128, v216
    v_xor_b32 v221, 160, v216
    v_xor_b32 v222, 192, v216
    v_xor_b32 v223, 224, v216
    v_lshrrev_b32 v2, 5, v1
    v_lshl_add_u32 v2, v2, 8, v249
    s_lshl_b32 s81, s29, 2
    v_add_u32 v248, s81, v2
    s_lshl_b32 s81, s29, 11
    s_add_u32 s81, s81, 131072
    v_add_u32 v252, s81, v7
    s_lshl_b32 s80, s7, 16
    s_lshl_b32 s81, s29, 14
    s_add_u32 s80, s80, s81
    s_add_u32 s80, s80, 1114112
    s_add_u32 s81, s80, 4096
    s_add_u32 s82, s80, 8192
    s_add_u32 s83, s80, 12288
    s_lshl_b32 s30, s29, 20
    s_lshl_b32 s78, s7, 10
    s_add_u32 s30, s30, s78
    s_lshr_b32 s78, s4, 1
    s_lshl_b32 s79, s78, 7
    s_add_u32 s30, s30, s79
    s_lshl_b32 s84, s7, 9
    s_add_u32 s84, s84, 8192
    s_mov_b32 s85, 100
    v_lshlrev_b32 v253, 3, v1
    s_waitcnt lgkmcnt(0)
    s_add_u32 s5, s5, 0x9e3779b9
    s_add_u32 s95, s95, s5
    s_cmp_lg_u32 s3, 6
    s_cbranch_scc1 L_nxt_36
    s_lshl_b32 s78, s7, 7
    s_bfe_u32 s79, s2, 0x10003
    s_lshl_b32 s79, s79, 11
    s_add_u32 s78, s78, s79
    s_lshl2_add_u32 s78, s4, s78
    v_mov_b32 v2, s95
    v_mov_b32 v3, 0
    s_mov_b64 exec, 1
    s_add_u32 s78, s78, 4096
    buffer_store_dword v2, v3, s[8:11], s78 offen sc1
    s_mov_b64 exec, -1
L_nxt_36:
    v_mov_b32 v2, -1
    v_mov_b32 v3, -1
    ds_write_b64 v223, v[2:3] offset:7680
    s_barrier
    ds_read_b128 v[8:11], v136 offset:0
    ds_read_b128 v[12:15], v137 offset:0
    ds_read_b128 v[16:19], v138 offset:0
    ds_read_b128 v[20:23], v139 offset:0
    ds_read_b128 v[24:27], v140 offset:0
    ds_read_b128 v[28:31], v141 offset:0
    ds_read_b128 v[32:35], v142 offset:0
    ds_read_b128 v[36:39], v143 offset:0
    ds_read_b128 v[40:43], v144 offset:0
    ds_read_b128 v[44:47], v145 offset:0
    ds_read_b128 v[48:51], v146 offset:0
    ds_read_b128 v[52:55], v147 offset:0
    ds_read_b128 v[56:59], v148 offset:0
    ds_read_b128 v[60:63], v149 offset:0
    ds_read_b128 v[64:67], v150 offset:0
    ds_read_b128 v[68:71], v151 offset:0
    s_waitcnt lgkmcnt(0)
    s_barrier
    s_cmp_lg_u32 s3, 7
    s_cbranch_scc1 L_A_ng2
    s_waitcnt vmcnt(0)
    v_mov_b32 v2, 0
    v_mov_b32 v3, 0
    v_dot2c_f32_bf16 v2, v152, v168
    v_dot2c_f32_bf16 v3, v153, v169
    v_dot2c_f32_bf16 v2, v154, v170
    v_dot2c_f32_bf16 v3, v155, v171
    v_dot2c_f32_bf16 v2, v156, v172
    v_dot2c_f32_bf16 v3, v157, v173
    v_dot2c_f32_bf16 v2, v158, v174
    v_dot2c_f32_bf16 v3, v159, v175
    v_dot2c_f32_bf16 v2, v160, v176
    v_dot2c_f32_bf16 v3, v161, v177
    v_dot2c_f32_bf16 v2, v162, v178
    v_dot2c_f32_bf16 v3, v163, v179
    v_dot2c_f32_bf16 v2, v164, v180
    v_dot2c_f32_bf16 v3, v165, v181
    v_dot2c_f32_bf16 v2, v166, v182
    v_dot2c_f32_bf16 v3, v167, v183
    s_nop 3
    v_add_f32 v2, v2, v3
    s_nop 1
    v_add_f32_dpp v2, v2, v2 row_ror:4 row_mask:0xf bank_mask:0xf
    s_nop 1
    v_add_f32_dpp v2, v2, v2 row_ror:8 row_mask:0xf bank_mask:0xf
    v_mov_b32 v3, v2
    s_nop 1
    v_permlane16_swap_b32 v2, v3
    v_add_f32 v2, v2, v3
    v_mov_b32 v3, v2
    s_nop 1
    v_permlane32_swap_b32 v2, v3
    v_add_f32 v2, v2, v3
    v_mul_f32 v2, 0xbfb8aa3b, v2
    v_exp_f32 v2, v2
    s_nop 0
    v_add_f32 v2, 1.0, v2
    v_rcp_f32 v250, v2
L_A_ng2:
    s_barrier
    ds_read_b128 v[72:75], v136 offset:16384
    ds_read_b128 v[76:79], v137 offset:16384
    ds_read_b128 v[80:83], v138 offset:16384
    ds_read_b128 v[84:87], v139 offset:16384
    ds_read_b128 v[88:91], v140 offset:16384
    ds_read_b128 v[92:95], v141 offset:16384
    ds_read_b128 v[96:99], v142 offset:16384
    ds_read_b128 v[100:103], v143 offset:16384
    ds_read_b128 v[104:107], v144 offset:16384
    ds_read_b128 v[108:111], v145 offset:16384
    ds_read_b128 v[112:115], v146 offset:16384
    ds_read_b128 v[116:119], v147 offset:16384
    ds_read_b128 v[120:123], v148 offset:16384
    ds_read_b128 v[124:127], v149 offset:16384
    ds_read_b128 v[128:131], v150 offset:16384
    ds_read_b128 v[132:135], v151 offset:16384
    s_waitcnt lgkmcnt(0)
    s_barrier
    buffer_load_dwordx2 v[224:225], v253, s[8:11], s84 offen sc1
    s_sleep 6
    buffer_load_dwordx2 v[226:227], v253, s[8:11], s84 offen sc1
    s_sleep 6
L_A_hp:
    buffer_load_dwordx2 v[228:229], v253, s[8:11], s84 offen sc1
    s_waitcnt vmcnt(2)
    v_cmp_eq_u32 vcc, s5, v224
    v_cmp_eq_u32 s[78:79], s5, v225
    s_nop 1
    s_and_b64 s[78:79], s[78:79], vcc
    s_cmp_eq_u64 s[78:79], -1
    s_cbranch_scc1 L_A_hq
    s_sleep 6
    buffer_load_dwordx2 v[224:225], v253, s[8:11], s84 offen sc1
    s_waitcnt vmcnt(2)
    v_cmp_eq_u32 vcc, s5, v226
    v_cmp_eq_u32 s[78:79], s5, v227
    s_nop 1
    s_and_b64 s[78:79], s[78:79], vcc
    s_cmp_eq_u64 s[78:79], -1
    s_cbranch_scc1 L_A_hq
    s_sleep 6
    buffer_load_dwordx2 v[226:227], v253, s[8:11], s84 offen sc1
    s_waitcnt vmcnt(2)
    v_cmp_eq_u32 vcc, s5, v228
    v_cmp_eq_u32 s[78:79], s5, v229
    s_nop 1
    s_and_b64 s[78:79], s[78:79], vcc
    s_cmp_eq_u64 s[78:79], -1
    s_cbranch_scc1 L_A_hq
    s_sleep 6
    s_sub_u32 s85, s85, 1
    s_cmp_gt_i32 s85, 0
    s_cbranch_scc1 L_A_hp
L_A_hq:
    buffer_load_dwordx4 v[152:155], v7, s[8:11], s80 offen offset:0
    buffer_load_dwordx4 v[156:159], v7, s[8:11], s80 offen offset:1024
    buffer_load_dwordx4 v[160:163], v7, s[8:11], s80 offen offset:2048
    buffer_load_dwordx4 v[164:167], v7, s[8:11], s80 offen offset:3072
    buffer_load_dwordx4 v[168:171], v7, s[8:11], s81 offen offset:0
    buffer_load_dwordx4 v[172:175], v7, s[8:11], s81 offen offset:1024
    buffer_load_dwordx4 v[176:179], v7, s[8:11], s81 offen offset:2048
    buffer_load_dwordx4 v[180:183], v7, s[8:11], s81 offen offset:3072
    buffer_load_dwordx4 v[184:187], v7, s[8:11], s82 offen offset:0
    buffer_load_dwordx4 v[188:191], v7, s[8:11], s82 offen offset:1024
    buffer_load_dwordx4 v[192:195], v7, s[8:11], s82 offen offset:2048
    buffer_load_dwordx4 v[196:199], v7, s[8:11], s82 offen offset:3072
    buffer_load_dwordx4 v[200:203], v7, s[8:11], s83 offen offset:0
    buffer_load_dwordx4 v[204:207], v7, s[8:11], s83 offen offset:1024
    buffer_load_dwordx4 v[208:211], v7, s[8:11], s83 offen offset:2048
    buffer_load_dwordx4 v[212:215], v7, s[8:11], s83 offen offset:3072
    s_waitcnt vmcnt(12)
L_poll_37:
    s_mov_b64 s[0:1], exec
    v_cmpx_eq_u32 vcc, s5, v155
    v_cmpx_eq_u32 vcc, s5, v159
    v_cmpx_eq_u32 vcc, s5, v163
    v_cmpx_eq_u32 vcc, s5, v167
    s_andn2_b64 exec, s[0:1], exec
    s_cbranch_scc0 L_got_38
    buffer_load_dwordx4 v[152:155], v7, s[8:11], s80 offen offset:0 sc1
    buffer_load_dwordx4 v[156:159], v7, s[8:11], s80 offen offset:1024 sc1
    buffer_load_dwordx4 v[160:163], v7, s[8:11], s80 offen offset:2048 sc1
    buffer_load_dwordx4 v[164:167], v7, s[8:11], s80 offen offset:3072 sc1
    s_sub_u32 s6, s6, 1
    s_cmp_gt_i32 s6, 0
    s_waitcnt vmcnt(0)
    s_cbranch_scc1 L_poll_37
L_got_38:
    s_mov_b64 exec, -1
    s_nop 3
    ds_write_b64 v216, v[152:153] offset:0
    ds_write_b64 v216, v[156:157] offset:512
    ds_write_b64 v217, v[160:161] offset:1024
    ds_write_b64 v217, v[164:165] offset:1536
    s_waitcnt vmcnt(8)
L_poll_39:
    s_mov_b64 s[0:1], exec
    v_cmpx_eq_u32 vcc, s5, v171
    v_cmpx_eq_u32 vcc, s5, v175
    v_cmpx_eq_u32 vcc, s5, v179
    v_cmpx_eq_u32 vcc, s5, v183
    s_andn2_b64 exec, s[0:1], exec
    s_cbranch_scc0 L_got_40
    buffer_load_dwordx4 v[168:171], v7, s[8:11], s81 offen offset:0 sc1
    buffer_load_dwordx4 v[172:175], v7, s[8:11], s81 offen offset:1024 sc1
    buffer_load_dwordx4 v[176:179], v7, s[8:11], s81 offen offset:2048 sc1
    buffer_load_dwordx4 v[180:183], v7, s[8:11], s81 offen offset:3072 sc1
    s_sub_u32 s6, s6, 1
    s_cmp_gt_i32 s6, 0
    s_waitcnt vmcnt(0)
    s_cbranch_scc1 L_poll_39
L_got_40:
    s_mov_b64 exec, -1
    s_nop 3
    ds_write_b64 v218, v[168:169] offset:2048
    ds_write_b64 v218, v[172:173] offset:2560
    ds_write_b64 v219, v[176:177] offset:3072
    ds_write_b64 v219, v[180:181] offset:3584
    s_waitcnt vmcnt(4)
L_poll_41:
    s_mov_b64 s[0:1], exec
    v_cmpx_eq_u32 vcc, s5, v187
    v_cmpx_eq_u32 vcc, s5, v191
    v_cmpx_eq_u32 vcc, s5, v195
    v_cmpx_eq_u32 vcc, s5, v199
    s_andn2_b64 exec, s[0:1], exec
    s_cbranch_scc0 L_got_42
    buffer_load_dwordx4 v[184:187], v7, s[8:11], s82 offen offset:0 sc1
    buffer_load_dwordx4 v[188:191], v7, s[8:11], s82 offen offset:1024 sc1
    buffer_load_dwordx4 v[192:195], v7, s[8:11], s82 offen offset:2048 sc1
    buffer_load_dwordx4 v[196:199], v7, s[8:11], s82 offen offset:3072 sc1
    s_sub_u32 s6, s6, 1
    s_cmp_gt_i32 s6, 0
    s_waitcnt vmcnt(0)
    s_cbranch_scc1 L_poll_41
L_got_42:
    s_mov_b64 exec, -1
    s_nop 3
    ds_write_b64 v220, v[184:185] offset:4096
    ds_write_b64 v220, v[188:189] offset:4608
    ds_write_b64 v221, v[192:193] offset:5120
    ds_write_b64 v221, v[196:197] offset:5632
    s_waitcnt vmcnt(0)
L_poll_43:
    s_mov_b64 s[0:1], exec
    v_cmpx_eq_u32 vcc, s5, v203
    v_cmpx_eq_u32 vcc, s5, v207
    v_cmpx_eq_u32 vcc, s5, v211
    v_cmpx_eq_u32 vcc, s5, v215
    s_andn2_b64 exec, s[0:1], exec
    s_cbranch_scc0 L_got_44
    buffer_load_dwordx4 v[200:203], v7, s[8:11], s83 offen offset:0 sc1
    buffer_load_dwordx4 v[204:207], v7, s[8:11], s83 offen offset:1024 sc1
    buffer_load_dwordx4 v[208:211], v7, s[8:11], s83 offen offset:2048 sc1
    buffer_load_dwordx4 v[212:215], v7, s[8:11], s83 offen offset:3072 sc1
    s_sub_u32 s6, s6, 1
    s_cmp_gt_i32 s6, 0
    s_waitcnt vmcnt(0)
    s_cbranch_scc1 L_poll_43
L_got_44:
    s_mov_b64 exec, -1
    s_nop 3
    ds_write_b64 v222, v[200:201] offset:6144
    ds_write_b64 v222, v[204:205] offset:6656
    ds_write_b64 v223, v[208:209] offset:7168
    ds_write_b64 v223, v[212:213] offset:7680
    s_waitcnt lgkmcnt(0)
    v_add_u32 v224, 138752, v253
    s_mov_b32 s85, 400000
L_A_qe:
    ds_read_b64 v[152:153], v224 offset:0
    ds_read_b64 v[154:155], v224 offset:8192
    ds_read_b64 v[156:157], v224 offset:16384
    ds_read_b64 v[158:159], v224 offset:24576
    s_waitcnt lgkmcnt(0)
    v_max3_u32 v2, v152, v153, v154
    v_max3_u32 v3, v155, v156, v157
    v_max3_u32 v2, v2, v158, v159
    v_max_u32 v2, v2, v3
    v_cmp_eq_u32 vcc, -1, v2
    s_nop 4
    s_cbranch_vccz L_A_qf
    s_sleep 2
    s_sub_u32 s85, s85, 1
    s_cmp_gt_i32 s85, 0
    s_cbranch_scc1 L_A_qe
L_A_qf:
    ds_read_b128 v[152:155], v232 offset:0
    ds_read_b128 v[156:159], v232 offset:16384
    ds_read_b128 v[160:163], v233 offset:0
    ds_read_b128 v[164:167], v233 offset:16384
    ds_read_b128 v[168:171], v234 offset:0
    ds_read_b128 v[172:175], v234 offset:16384
    ds_read_b128 v[176:179], v235 offset:0
    ds_read_b128 v[180:183], v235 offset:16384
    s_waitcnt lgkmcnt(6)
    v_mfma_f32_16x16x32_bf16 v[200:203], v[8:11], v[152:155], 0
    v_mfma_f32_16x16x32_bf16 v[208:211], v[8:11], v[156:159], 0
    v_mfma_f32_16x16x32_bf16 v[204:207], v[72:75], v[152:155], 0
    v_mfma_f32_16x16x32_bf16 v[212:215], v[72:75], v[156:159], 0
    ds_read_b128 v[8:11], v232 offset:0
    ds_read_b128 v[72:75], v232 offset:16384
    ds_read_b128 v[152:155], v236 offset:0
    ds_read_b128 v[156:159], v236 offset:16384
    s_waitcnt lgkmcnt(8)
    v_mfma_f32_16x16x32_bf16 v[200:203], v[12:15], v[160:163], v[200:203]
    v_mfma_f32_16x16x32_bf16 v[208:211], v[12:15], v[164:167], v[208:211]
    v_mfma_f32_16x16x32_bf16 v[204:207], v[76:79], v[160:163], v[204:207]
    v_mfma_f32_16x16x32_bf16 v[212:215], v[76:79], v[164:167], v[212:215]
    ds_read_b128 v[12:15], v233 offset:0
    ds_read_b128 v[76:79], v233 offset:16384
    ds_read_b128 v[160:163], v237 offset:0
    ds_read_b128 v[164:167], v237 offset:16384
    s_waitcnt lgkmcnt(10)
    v_mfma_f32_16x16x32_bf16 v[200:203], v[16:19], v[168:171], v[200:203]
    v_mfma_f32_16x16x32_bf16 v[208:211], v[16:19], v[172:175], v[208:211]
    v_mfma_f32_16x16x32_bf16 v[204:207], v[80:83], v[168:171], v[204:207]
    v_mfma_f32_16x16x32_bf16 v[212:215], v[80:83], v[172:175], v[212:215]
    ds_read_b128 v[16:19], v234 offset:0
    ds_read_b128 v[80:83], v234 offset:16384
    ds_read_b128 v[168:171], v238 offset:0
    ds_read_b128 v[172:175], v238 offset:16384
    s_waitcnt lgkmcnt(12)
    v_mfma_f32_16x16x32_bf16 v[200:203], v[20:23], v[176:179], v[200:203]
    v_mfma_f32_16x16x32_bf16 v[208:211], v[20:23], v[180:183], v[208:211]
    v_mfma_f32_16x16x32_bf16 v[204:207], v[84:87], v[176:179], v[204:207]
    v_mfma_f32_16x16x32_bf16 v[212:215], v[84:87], v[180:183], v[212:215]
    ds_read_b128 v[20:23], v235 offset:0
    ds_read_b128 v[84:87], v235 offset:16384
    ds_read_b128 v[176:179], v239 offset:0
    ds_read_b128 v[180:183], v239 offset:16384
    s_waitcnt lgkmcnt(12)
    v_mfma_f32_16x16x32_bf16 v[200:203], v[24:27], v[152:155], v[200:203]
    v_mfma_f32_16x16x32_bf16 v[208:211], v[24:27], v[156:159], v[208:211]
    v_mfma_f32_16x16x32_bf16 v[204:207], v[88:91], v[152:155], v[204:207]
    v_mfma_f32_16x16x32_bf16 v[212:215], v[88:91], v[156:159], v[212:215]
    ds_read_b128 v[24:27], v236 offset:0
    ds_read_b128 v[88:91], v236 offset:16384
    ds_read_b128 v[152:155], v240 offset:0
    ds_read_b128 v[156:159], v240 offset:16384
    s_waitcnt lgkmcnt(12)
    v_mfma_f32_16x16x32_bf16 v[200:203], v[28:31], v[160:163], v[200:203]
    v_mfma_f32_16x16x32_bf16 v[208:211], v[28:31], v[164:167], v[208:211]
    v_mfma_f32_16x16x32_bf16 v[204:207], v[92:95], v[160:163], v[204:207]
    v_mfma_f32_16x16x32_bf16 v[212:215], v[92:95], v[164:167], v[212:215]
    ds_read_b128 v[28:31], v237 offset:0
    ds_read_b128 v[92:95], v237 offset:16384
    ds_read_b128 v[160:163], v241 offset:0
    ds_read_b128 v[164:167], v241 offset:16384
    s_waitcnt lgkmcnt(12)
    v_mfma_f32_16x16x32_bf16 v[200:203], v[32:35], v[168:171], v[200:203]
    v_mfma_f32_16x16x32_bf16 v[208:211], v[32:35], v[172:175], v[208:211]
    v_mfma_f32_16x16x32_bf16 v[204:207], v[96:99], v[168:171], v[204:207]
    v_mfma_f32_16x16x32_bf16 v[212:215], v[96:99], v[172:175], v[212:215]
    ds_read_b128 v[32:35], v238 offset:0
    ds_read_b128 v[96:99], v238 offset:16384
    ds_read_b128 v[168:171], v242 offset:0
    ds_read_b128 v[172:175], v242 offset:16384
    s_waitcnt lgkmcnt(12)
    v_mfma_f32_16x16x32_bf16 v[200:203], v[36:39], v[176:179], v[200:203]
    v_mfma_f32_16x16x32_bf16 v[208:211], v[36:39], v[180:183], v[208:211]
    v_mfma_f32_16x16x32_bf16 v[204:207], v[100:103], v[176:179], v[204:207]
    v_mfma_f32_16x16x32_bf16 v[212:215], v[100:103], v[180:183], v[212:215]
    ds_read_b128 v[36:39], v239 offset:0
    ds_read_b128 v[100:103], v239 offset:16384
    ds_read_b128 v[176:179], v243 offset:0
    ds_read_b128 v[180:183], v243 offset:16384
    s_waitcnt lgkmcnt(12)
    v_mfma_f32_16x16x32_bf16 v[200:203], v[40:43], v[152:155], v[200:203]
    v_mfma_f32_16x16x32_bf16 v[208:211], v[40:43], v[156:159], v[208:211]
    v_mfma_f32_16x16x32_bf16 v[204:207], v[104:107], v[152:155], v[204:207]
    v_mfma_f32_16x16x32_bf16 v[212:215], v[104:107], v[156:159], v[212:215]
    ds_read_b128 v[40:43], v240 offset:0
    ds_read_b128 v[104:107], v240 offset:16384
    ds_read_b128 v[152:155], v244 offset:0
    ds_read_b128 v[156:159], v244 offset:16384
    s_waitcnt lgkmcnt(12)
    v_mfma_f32_16x16x32_bf16 v[200:203], v[44:47], v[160:163], v[200:203]
    v_mfma_f32_16x16x32_bf16 v[208:211], v[44:47], v[164:167], v[208:211]
    v_mfma_f32_16x16x32_bf16 v[204:207], v[108:111], v[160:163], v[204:207]
    v_mfma_f32_16x16x32_bf16 v[212:215], v[108:111], v[164:167], v[212:215]
    ds_read_b128 v[44:47], v241 offset:0
    ds_read_b128 v[108:111], v241 offset:16384
    ds_read_b128 v[160:163], v245 offset:0
    ds_read_b128 v[164:167], v245 offset:16384
    s_waitcnt lgkmcnt(12)
    v_mfma_f32_16x16x32_bf16 v[200:203], v[48:51], v[168:171], v[200:203]
    v_mfma_f32_16x16x32_bf16 v[208:211], v[48:51], v[172:175], v[208:211]
    v_mfma_f32_16x16x32_bf16 v[204:207], v[112:115], v[168:171], v[204:207]
    v_mfma_f32_16x16x32_bf16 v[212:215], v[112:115], v[172:175], v[212:215]
    ds_read_b128 v[48:51], v242 offset:0
    ds_read_b128 v[112:115], v242 offset:16384
    ds_read_b128 v[168:171], v246 offset:0
    ds_read_b128 v[172:175], v246 offset:16384
    s_waitcnt lgkmcnt(12)
    v_mfma_f32_16x16x32_bf16 v[200:203], v[52:55], v[176:179], v[200:203]
    v_mfma_f32_16x16x32_bf16 v[208:211], v[52:55], v[180:183], v[208:211]
    v_mfma_f32_16x16x32_bf16 v[204:207], v[116:119], v[176:179], v[204:207]
    v_mfma_f32_16x16x32_bf16 v[212:215], v[116:119], v[180:183], v[212:215]
    ds_read_b128 v[52:55], v243 offset:0
    ds_read_b128 v[116:119], v243 offset:16384
    ds_read_b128 v[176:179], v247 offset:0
    ds_read_b128 v[180:183], v247 offset:16384
    s_waitcnt lgkmcnt(12)
    v_mfma_f32_16x16x32_bf16 v[200:203], v[56:59], v[152:155], v[200:203]
    v_mfma_f32_16x16x32_bf16 v[208:211], v[56:59], v[156:159], v[208:211]
    v_mfma_f32_16x16x32_bf16 v[204:207], v[120:123], v[152:155], v[204:207]
    v_mfma_f32_16x16x32_bf16 v[212:215], v[120:123], v[156:159], v[212:215]
    ds_read_b128 v[56:59], v244 offset:0
    ds_read_b128 v[120:123], v244 offset:16384
    s_waitcnt lgkmcnt(10)
    v_mfma_f32_16x16x32_bf16 v[200:203], v[60:63], v[160:163], v[200:203]
    v_mfma_f32_16x16x32_bf16 v[208:211], v[60:63], v[164:167], v[208:211]
    v_mfma_f32_16x16x32_bf16 v[204:207], v[124:127], v[160:163], v[204:207]
    v_mfma_f32_16x16x32_bf16 v[212:215], v[124:127], v[164:167], v[212:215]
    ds_read_b128 v[60:63], v245 offset:0
    ds_read_b128 v[124:127], v245 offset:16384
    s_waitcnt lgkmcnt(8)
    v_mfma_f32_16x16x32_bf16 v[200:203], v[64:67], v[168:171], v[200:203]
    v_mfma_f32_16x16x32_bf16 v[208:211], v[64:67], v[172:175], v[208:211]
    v_mfma_f32_16x16x32_bf16 v[204:207], v[128:131], v[168:171], v[204:207]
    v_mfma_f32_16x16x32_bf16 v[212:215], v[128:131], v[172:175], v[212:215]
    ds_read_b128 v[64:67], v246 offset:0
    ds_read_b128 v[128:131], v246 offset:16384
    s_waitcnt lgkmcnt(6)
    v_mfma_f32_16x16x32_bf16 v[200:203], v[68:71], v[176:179], v[200:203]
    v_mfma_f32_16x16x32_bf16 v[208:211], v[68:71], v[180:183], v[208:211]
    v_mfma_f32_16x16x32_bf16 v[204:207], v[132:135], v[176:179], v[204:207]
    v_mfma_f32_16x16x32_bf16 v[212:215], v[132:135], v[180:183], v[212:215]
    ds_read_b128 v[68:71], v247 offset:0
    ds_read_b128 v[132:135], v247 offset:16384
    s_waitcnt lgkmcnt(0)
    s_barrier
    ds_read_b128 v[152:155], v136 offset:0
    ds_read_b128 v[156:159], v136 offset:16384
    ds_read_b128 v[160:163], v137 offset:0
    ds_read_b128 v[164:167], v137 offset:16384
    ds_read_b128 v[168:171], v138 offset:0
    ds_read_b128 v[172:175], v138 offset:16384
    ds_read_b128 v[176:179], v139 offset:0
    ds_read_b128 v[180:183], v139 offset:16384
    ds_read_b128 v[184:187], v140 offset:0
    ds_read_b128 v[188:191], v140 offset:16384
    ds_read_b128 v[192:195], v141 offset:0
    ds_read_b128 v[196:199], v141 offset:16384
    s_waitcnt lgkmcnt(11)
    v_mfma_f32_16x16x32_bf16 v[216:219], v[152:155], v[8:11], 0
    v_bfe_u32 v2, v1, 4, 1
    v_mfma_f32_16x16x32_bf16 v[224:227], v[152:155], v[72:75], 0
    v_lshlrev_b32 v2, 1, v2
    s_waitcnt lgkmcnt(10)
    v_mfma_f32_16x16x32_bf16 v[220:223], v[156:159], v[8:11], 0
    v_xor_b32 v2, v2, v4
    v_mfma_f32_16x16x32_bf16 v[228:231], v[156:159], v[72:75], 0
    v_lshlrev_b32 v2, 4, v2
    ds_read_b128 v[152:155], v142 offset:0
    ds_read_b128 v[156:159], v142 offset:16384
    s_waitcnt lgkmcnt(11)
    v_mfma_f32_16x16x32_bf16 v[216:219], v[160:163], v[12:15], v[216:219]
    v_lshrrev_b32 v3, 3, v1
    v_mfma_f32_16x16x32_bf16 v[224:227], v[160:163], v[76:79], v[224:227]
    v_lshl_add_u32 v136, v3, 13, v2
    s_waitcnt lgkmcnt(10)
    v_mfma_f32_16x16x32_bf16 v[220:223], v[164:167], v[12:15], v[220:223]
    v_xor_b32 v137, 64, v136
    v_mfma_f32_16x16x32_bf16 v[228:231], v[164:167], v[76:79], v[228:231]
    ds_read_b128 v[160:163], v143 offset:0
    ds_read_b128 v[164:167], v143 offset:16384
    s_waitcnt lgkmcnt(11)
    v_mfma_f32_16x16x32_bf16 v[216:219], v[168:171], v[16:19], v[216:219]
    v_mfma_f32_16x16x32_bf16 v[224:227], v[168:171], v[80:83], v[224:227]
    s_waitcnt lgkmcnt(10)
    v_mfma_f32_16x16x32_bf16 v[220:223], v[172:175], v[16:19], v[220:223]
    v_mfma_f32_16x16x32_bf16 v[228:231], v[172:175], v[80:83], v[228:231]
    buffer_load_dwordx4 v[8:11], v136, s[16:19], s30 offen nt
    s_add_u32 s30, s30, 65536
    ds_read_b128 v[168:171], v144 offset:0
    ds_read_b128 v[172:175], v144 offset:16384
    s_waitcnt lgkmcnt(11)
    v_mfma_f32_16x16x32_bf16 v[216:219], v[176:179], v[20:23], v[216:219]
    v_mfma_f32_16x16x32_bf16 v[224:227], v[176:179], v[84:87], v[224:227]
    s_waitcnt lgkmcnt(10)
    v_mfma_f32_16x16x32_bf16 v[220:223], v[180:183], v[20:23], v[220:223]
    v_mfma_f32_16x16x32_bf16 v[228:231], v[180:183], v[84:87], v[228:231]
    buffer_load_dwordx4 v[12:15], v137, s[16:19], s30 offen nt
    s_add_u32 s30, s30, 65536
    ds_read_b128 v[176:179], v145 offset:0
    ds_read_b128 v[180:183], v145 offset:16384
    s_waitcnt lgkmcnt(11)
    v_mfma_f32_16x16x32_bf16 v[216:219], v[184:187], v[24:27], v[216:219]
    v_mfma_f32_16x16x32_bf16 v[224:227], v[184:187], v[88:91], v[224:227]
    s_waitcnt lgkmcnt(10)
    v_mfma_f32_16x16x32_bf16 v[220:223], v[188:191], v[24:27], v[220:223]
    v_mfma_f32_16x16x32_bf16 v[228:231], v[188:191], v[88:91], v[228:231]
    buffer_load_dwordx4 v[16:19], v136, s[16:19], s30 offen nt
    s_add_u32 s30, s30, 65536
    ds_read_b128 v[184:187], v146 offset:0
    ds_read_b128 v[188:191], v146 offset:16384
    s_waitcnt lgkmcnt(11)
    v_mfma_f32_16x16x32_bf16 v[216:219], v[192:195], v[28:31], v[216:219]
    v_mfma_f32_16x16x32_bf16 v[224:227], v[192:195], v[92:95], v[224:227]
    s_waitcnt lgkmcnt(10)
    v_mfma_f32_16x16x32_bf16 v[220:223], v[196:199], v[28:31], v[220:223]
    v_mfma_f32_16x16x32_bf16 v[228:231], v[196:199], v[92:95], v[228:231]
    buffer_load_dwordx4 v[20:23], v137, s[16:19], s30 offen nt
    s_add_u32 s30, s30, 65536
    ds_read_b128 v[192:195], v147 offset:0
    ds_read_b128 v[196:199], v147 offset:16384
    s_waitcnt lgkmcnt(11)
    v_mfma_f32_16x16x32_bf16 v[216:219], v[152:155], v[32:35], v[216:219]
    v_mfma_f32_16x16x32_bf16 v[224:227], v[152:155], v[96:99], v[224:227]
    s_waitcnt lgkmcnt(10)
    v_mfma_f32_16x16x32_bf16 v[220:223], v[156:159], v[32:35], v[220:223]
    v_mfma_f32_16x16x32_bf16 v[228:231], v[156:159], v[96:99], v[228:231]
    buffer_load_dwordx4 v[24:27], v136, s[16:19], s30 offen nt
    s_add_u32 s30, s30, 65536
    ds_read_b128 v[152:155], v148 offset:0
    ds_read_b128 v[156:159], v148 offset:16384
    s_waitcnt lgkmcnt(11)
    v_mfma_f32_16x16x32_bf16 v[216:219], v[160:163], v[36:39], v[216:219]
    v_mfma_f32_16x16x32_bf16 v[224:227], v[160:163], v[100:103], v[224:227]
    s_waitcnt lgkmcnt(10)
    v_mfma_f32_16x16x32_bf16 v[220:223], v[164:167], v[36:39], v[220:223]
    v_mfma_f32_16x16x32_bf16 v[228:231], v[164:167], v[100:103], v[228:231]
    buffer_load_dwordx4 v[28:31], v137, s[16:19], s30 offen nt
    s_add_u32 s30, s30, 65536
    ds_read_b128 v[160:163], v149 offset:0
    ds_read_b128 v[164:167], v149 offset:16384
    s_waitcnt lgkmcnt(11)
    v_mfma_f32_16x16x32_bf16 v[216:219], v[168:171], v[40:43], v[216:219]
    v_mfma_f32_16x16x32_bf16 v[224:227], v[168:171], v[104:107], v[224:227]
    s_waitcnt lgkmcnt(10)
    v_mfma_f32_16x16x32_bf16 v[220:223], v[172:175], v[40:43], v[220:223]
    v_mfma_f32_16x16x32_bf16 v[228:231], v[172:175], v[104:107], v[228:231]
    buffer_load_dwordx4 v[32:35], v136, s[16:19], s30 offen nt
    s_add_u32 s30, s30, 65536
    ds_read_b128 v[168:171], v150 offset:0
    ds_read_b128 v[172:175], v150 offset:16384
    s_waitcnt lgkmcnt(11)
    v_mfma_f32_16x16x32_bf16 v[216:219], v[176:179], v[44:47], v[216:219]
    v_mfma_f32_16x16x32_bf16 v[224:227], v[176:179], v[108:111], v[224:227]
    s_waitcnt lgkmcnt(10)
    v_mfma_f32_16x16x32_bf16 v[220:223], v[180:183], v[44:47], v[220:223]
    v_mfma_f32_16x16x32_bf16 v[228:231], v[180:183], v[108:111], v[228:231]
    buffer_load_dwordx4 v[36:39], v137, s[16:19], s30 offen nt
    s_add_u32 s30, s30, 65536
    ds_read_b128 v[176:179], v151 offset:0
    ds_read_b128 v[180:183], v151 offset:16384
    s_waitcnt lgkmcnt(11)
    v_mfma_f32_16x16x32_bf16 v[216:219], v[184:187], v[48:51], v[216:219]
    v_mfma_f32_16x16x32_bf16 v[224:227], v[184:187], v[112:115], v[224:227]
    s_waitcnt lgkmcnt(10)
    v_mfma_f32_16x16x32_bf16 v[220:223], v[188:191], v[48:51], v[220:223]
    v_mfma_f32_16x16x32_bf16 v[228:231], v[188:191], v[112:115], v[228:231]
    buffer_load_dwordx4 v[40:43], v136, s[16:19], s30 offen nt
    s_add_u32 s30, s30, 65536
    s_waitcnt lgkmcnt(9)
    v_mfma_f32_16x16x32_bf16 v[216:219], v[192:195], v[52:55], v[216:219]
    v_mfma_f32_16x16x32_bf16 v[224:227], v[192:195], v[116:119], v[224:227]
    s_waitcnt lgkmcnt(8)
    v_mfma_f32_16x16x32_bf16 v[220:223], v[196:199], v[52:55], v[220:223]
    v_mfma_f32_16x16x32_bf16 v[228:231], v[196:199], v[116:119], v[228:231]
    buffer_load_dwordx4 v[44:47], v137, s[16:19], s30 offen nt
    s_add_u32 s30, s30, 65536
    s_waitcnt lgkmcnt(7)
    v_mfma_f32_16x16x32_bf16 v[216:219], v[152:155], v[56:59], v[216:219]
    v_mfma_f32_16x16x32_bf16 v[224:227], v[152:155], v[120:123], v[224:227]
    s_waitcnt lgkmcnt(6)
    v_mfma_f32_16x16x32_bf16 v[220:223], v[156:159], v[56:59], v[220:223]
    v_mfma_f32_16x16x32_bf16 v[228:231], v[156:159], v[120:123], v[228:231]
    buffer_load_dwordx4 v[48:51], v136, s[16:19], s30 offen nt
    s_add_u32 s30, s30, 65536
    s_waitcnt lgkmcnt(5)
    v_mfma_f32_16x16x32_bf16 v[216:219], v[160:163], v[60:63], v[216:219]
    v_mfma_f32_16x16x32_bf16 v[224:227], v[160:163], v[124:127], v[224:227]
    s_waitcnt lgkmcnt(4)
    v_mfma_f32_16x16x32_bf16 v[220:223], v[164:167], v[60:63], v[220:223]
    v_mfma_f32_16x16x32_bf16 v[228:231], v[164:167], v[124:127], v[228:231]
    buffer_load_dwordx4 v[52:55], v137, s[16:19], s30 offen nt
    s_add_u32 s30, s30, 65536
    s_waitcnt lgkmcnt(3)
    v_mfma_f32_16x16x32_bf16 v[216:219], v[168:171], v[64:67], v[216:219]
    v_mfma_f32_16x16x32_bf16 v[224:227], v[168:171], v[128:131], v[224:227]
    s_waitcnt lgkmcnt(2)
    v_mfma_f32_16x16x32_bf16 v[220:223], v[172:175], v[64:67], v[220:223]
    v_mfma_f32_16x16x32_bf16 v[228:231], v[172:175], v[128:131], v[228:231]
    s_waitcnt lgkmcnt(0)
    s_barrier
    v_mfma_f32_16x16x32_bf16 v[216:219], v[176:179], v[68:71], v[216:219]
    v_mfma_f32_16x16x32_bf16 v[224:227], v[176:179], v[132:135], v[224:227]
    v_mfma_f32_16x16x32_bf16 v[220:223], v[180:183], v[68:71], v[220:223]
    v_mfma_f32_16x16x32_bf16 v[228:231], v[180:183], v[132:135], v[228:231]
    s_nop 7
    s_nop 7
    v_max3_f32 v2, v200, v201, v202
    v_max3_f32 v3, v208, v209, v210
    v_max3_f32 v2, v2, v203, v204
    v_max3_f32 v3, v3, v211, v212
    v_max3_f32 v2, v2, v205, v206
    v_max3_f32 v3, v3, v213, v214
    v_max3_f32 v2, v2, v207, v216
    v_max3_f32 v3, v3, v215, v224
    v_max3_f32 v2, v2, v217, v218
    v_max3_f32 v3, v3, v225, v226
    v_max3_f32 v2, v2, v219, v220
    v_max3_f32 v3, v3, v227, v228
    v_max3_f32 v2, v2, v221, v222
    v_max3_f32 v3, v3, v229, v230
    v_max_f32 v2, v2, v223
    v_max_f32 v3, v3, v231
    s_nop 1
    v_permlane32_swap_b32 v2, v3
    v_max_f32 v2, v2, v3
    v_mov_b32 v3, v2
    s_nop 1
    v_permlane16_swap_b32 v2, v3
    v_max_f32 v2, v2, v3
    ds_write_b32 v248, v2
    s_waitcnt lgkmcnt(0)
    s_barrier
    ds_read_b128 v[160:163], v249 offset:0
    ds_read_b128 v[164:167], v249 offset:256
    s_waitcnt lgkmcnt(1)
    v_max3_f32 v2, v160, v161, v162
    v_max_f32 v2, v2, v163
    s_waitcnt lgkmcnt(0)
    v_max3_f32 v3, v164, v165, v166
    v_max_f32 v3, v3, v167
    v_pk_add_f32 v[200:201], v[200:201], v[2:3] op_sel:[0,0] op_sel_hi:[1,0] neg_lo:[0,1] neg_hi:[0,1]
    v_pk_add_f32 v[202:203], v[202:203], v[2:3] op_sel:[0,0] op_sel_hi:[1,0] neg_lo:[0,1] neg_hi:[0,1]
    v_pk_add_f32 v[204:205], v[204:205], v[2:3] op_sel:[0,0] op_sel_hi:[1,0] neg_lo:[0,1] neg_hi:[0,1]
    v_pk_add_f32 v[206:207], v[206:207], v[2:3] op_sel:[0,0] op_sel_hi:[1,0] neg_lo:[0,1] neg_hi:[0,1]
    v_pk_add_f32 v[208:209], v[208:209], v[2:3] op_sel:[0,1] op_sel_hi:[1,1] neg_lo:[0,1] neg_hi:[0,1]
    v_pk_add_f32 v[210:211], v[210:211], v[2:3] op_sel:[0,1] op_sel_hi:[1,1] neg_lo:[0,1] neg_hi:[0,1]
    v_pk_add_f32 v[212:213], v[212:213], v[2:3] op_sel:[0,1] op_sel_hi:[1,1] neg_lo:[0,1] neg_hi:[0,1]
    v_pk_add_f32 v[214:215], v[214:215], v[2:3] op_sel:[0,1] op_sel_hi:[1,1] neg_lo:[0,1] neg_hi:[0,1]
    v_pk_add_f32 v[216:217], v[216:217], v[2:3] op_sel:[0,0] op_sel_hi:[1,0] neg_lo:[0,1] neg_hi:[0,1]
    v_pk_add_f32 v[218:219], v[218:219], v[2:3] op_sel:[0,0] op_sel_hi:[1,0] neg_lo:[0,1] neg_hi:[0,1]
    v_pk_add_f32 v[220:221], v[220:221], v[2:3] op_sel:[0,0] op_sel_hi:[1,0] neg_lo:[0,1] neg_hi:[0,1]
    v_pk_add_f32 v[222:223], v[222:223], v[2:3] op_sel:[0,0] op_sel_hi:[1,0] neg_lo:[0,1] neg_hi:[0,1]
    v_pk_add_f32 v[224:225], v[224:225], v[2:3] op_sel:[0,1] op_sel_hi:[1,1] neg_lo:[0,1] neg_hi:[0,1]
    v_pk_add_f32 v[226:227], v[226:227], v[2:3] op_sel:[0,1] op_sel_hi:[1,1] neg_lo:[0,1] neg_hi:[0,1]
    v_pk_add_f32 v[228:229], v[228:229], v[2:3] op_sel:[0,1] op_sel_hi:[1,1] neg_lo:[0,1] neg_hi:[0,1]
    v_pk_add_f32 v[230:231], v[230:231], v[2:3] op_sel:[0,1] op_sel_hi:[1,1] neg_lo:[0,1] neg_hi:[0,1]
    v_exp_f32 v200, v200
    v_exp_f32 v201, v201
    v_exp_f32 v202, v202
    v_exp_f32 v203, v203
    v_exp_f32 v204, v204
    v_exp_f32 v205, v205
    v_exp_f32 v206, v206
    v_exp_f32 v207, v207
    v_cvt_pk_bf16_f32 v168, v200, v201
    v_cvt_pk_bf16_f32 v169, v202, v203
    v_cvt_pk_bf16_f32 v170, v204, v205
    v_cvt_pk_bf16_f32 v171, v206, v207
    ds_write_b128 v252, v[168:171] offset:0
    v_exp_f32 v208, v208
    v_exp_f32 v209, v209
    v_exp_f32 v210, v210
    v_exp_f32 v211, v211
    v_exp_f32 v212, v212
    v_exp_f32 v213, v213
    v_exp_f32 v214, v214
    v_exp_f32 v215, v215
    v_cvt_pk_bf16_f32 v172, v208, v209
    v_cvt_pk_bf16_f32 v173, v210, v211
    v_cvt_pk_bf16_f32 v174, v212, v213
    v_cvt_pk_bf16_f32 v175, v214, v215
    ds_write_b128 v252, v[172:175] offset:1024
    s_waitcnt lgkmcnt(0)
    s_barrier
    v_exp_f32 v216, v216
    v_exp_f32 v217, v217
    v_exp_f32 v218, v218
    v_exp_f32 v219, v219
    v_exp_f32 v220, v220
    v_exp_f32 v221, v221
    v_exp_f32 v222, v222
    v_exp_f32 v223, v223
    v_cvt_pk_bf16_f32 v176, v216, v217
    v_cvt_pk_bf16_f32 v177, v218, v219
    v_cvt_pk_bf16_f32 v178, v220, v221
    v_cvt_pk_bf16_f32 v179, v222, v223
    ds_write_b128 v252, v[176:179] offset:8192
    v_exp_f32 v224, v224
    v_exp_f32 v225, v225
    v_exp_f32 v226, v226
    v_exp_f32 v227, v227
    v_exp_f32 v228, v228
    v_exp_f32 v229, v229
    v_exp_f32 v230, v230
    v_exp_f32 v231, v231
    v_cvt_pk_bf16_f32 v180, v224, v225
    v_cvt_pk_bf16_f32 v181, v226, v227
    v_cvt_pk_bf16_f32 v182, v228, v229
    v_cvt_pk_bf16_f32 v183, v230, v231
    ds_write_b128 v252, v[180:183] offset:9216
    s_waitcnt lgkmcnt(0)
    s_barrier
    v_add_f32 v2, v200, v201
    v_add_f32 v3, v208, v209
    v_add_f32 v2, v2, v202
    v_add_f32 v3, v3, v210
    v_add_f32 v2, v2, v203
    v_add_f32 v3, v3, v211
    v_add_f32 v2, v2, v204
    v_add_f32 v3, v3, v212
    v_add_f32 v2, v2, v205
    v_add_f32 v3, v3, v213
    v_add_f32 v2, v2, v206
    v_add_f32 v3, v3, v214
    v_add_f32 v2, v2, v207
    v_add_f32 v3, v3, v215
    v_add_f32 v2, v2, v216
    v_add_f32 v3, v3, v224
    v_add_f32 v2, v2, v217
    v_add_f32 v3, v3, v225
    v_add_f32 v2, v2, v218
    v_add_f32 v3, v3, v226
    v_add_f32 v2, v2, v219
    v_add_f32 v3, v3, v227
    v_add_f32 v2, v2, v220
    v_add_f32 v3, v3, v228
    v_add_f32 v2, v2, v221
    v_add_f32 v3, v3, v229
    v_add_f32 v2, v2, v222
    v_add_f32 v3, v3, v230
    v_add_f32 v2, v2, v223
    v_add_f32 v3, v3, v231
    s_nop 1
    v_permlane32_swap_b32 v2, v3
    v_add_f32 v2, v2, v3
    v_mov_b32 v3, v2
    s_nop 1
    v_permlane16_swap_b32 v2, v3
    v_add_f32 v2, v2, v3
    ds_write_b32 v248, v2 offset:512
    s_waitcnt lgkmcnt(0)
    s_barrier
    s_setprio 0
    buffer_load_dwordx4 v[56:59], v136, s[16:19], s30 offen nt
    s_add_u32 s30, s30, 65536
    buffer_load_dwordx4 v[60:63], v137, s[16:19], s30 offen nt
    s_add_u32 s30, s30, 65536
    buffer_load_dwordx4 v[64:67], v136, s[16:19], s30 offen nt
    s_add_u32 s30, s30, 65536
    buffer_load_dwordx4 v[68:71], v137, s[16:19], s30 offen nt
    s_add_u32 s30, s30, 65536
    s_mul_i32 s80, s7, 786432
    s_add_u32 s80, s80, 4194304
    s_lshl_b32 s81, s3, 7
    s_add_u32 s82, s80, s81
    s_mul_i32 s83, s4, 49152
    s_add_u32 s82, s82, s83
    s_add_u32 s83, s82, 24576
    s_mul_i32 s84, s4, 3072
    s_add_u32 s80, s80, s84
    s_lshl1_add_u32 s80, s81, s80
    s_add_u32 s81, s80, 393216
    v_and_b32 v2, 1, v1
    v_lshrrev_b32 v3, 3, v1
    v_mul_u32_u24 v240, 3072, v3
    v_lshl_add_u32 v240, v4, 4, v240
    v_lshlrev_b32 v241, 14, v2
    v_bfe_u32 v2, v1, 1, 2
    v_lshl_add_u32 v2, v5, 2, v2
    v_lshl_add_u32 v241, v2, 4, v241
    s_lshl_b32 s84, s4, 15
    s_lshl_b32 s85, s7, 11
    s_add_u32 s84, s84, s85
    s_lshl_b32 s85, s3, 8
    s_add_u32 s84, s84, s85
    s_add_u32 s84, s84, 1638400
    v_lshlrev_b32 v2, 7, v5
    v_lshl_add_u32 v2, v4, 4, v2
    v_lshrrev_b32 v3, 3, v6
    v_lshl_add_u32 v2, v3, 11, v2
    v_add_u32 v242, 151552, v2
    v_lshl_add_u32 v3, v3, 2, v5
    v_mul_u32_u24 v243, 0x3000, v3
    v_lshl_add_u32 v243, v4, 4, v243
    s_and_b32 s86, s4, 1
    s_lshl3_add_u32 s86, s86, s3
    s_mul_i32 s86, s86, 0x18000
    s_lshl_b32 s87, s7, 10
    s_add_u32 s86, s86, s87
    s_lshr_b32 s87, s4, 1
    s_lshl_b32 s87, s87, 7
    s_add_u32 s86, s86, s87
    s_add_u32 s86, s86, 2621440
    v_bfe_u32 v2, v1, 2, 3
    v_lshlrev_b32 v2, 1, v2
    v_bfe_u32 v3, v1, 1, 1
    s_lshl_b32 s87, s3, 2
    v_add_u32 v244, s87, v3
    v_xor_b32 v2, v2, v244
    v_lshrrev_b32 v244, 2, v1
    v_lshlrev_b32 v244, 9, v244
    v_lshl_add_u32 v244, v2, 4, v244
    v_and_b32 v2, 1, v1
    v_lshl_add_u32 v244, v2, 3, v244
    v_add_u32 v244, 16384, v244
    v_xor_b32 v246, 32, v244
    v_add_u32 v245, 0x10000, v244
    v_add_u32 v247, 0x10000, v246
    v_lshrrev_b32 v3, 3, v1
    v_lshlrev_b32 v232, 11, v4
    v_lshl_add_u32 v232, v3, 4, v232
    s_lshl_b32 s85, s88, 14
    s_lshl_b32 s87, s29, 9
    s_add_u32 s85, s85, s87
    s_add_u32 s85, s85, 1638400
    v_lshlrev_b32 v2, 7, v5
    v_lshl_add_u32 v2, v4, 4, v2
    s_lshl_b32 s87, s29, 10
    s_add_u32 s87, s87, 151552
    v_add_u32 v233, s87, v2
    v_bfe_u32 v2, v1, 3, 2
    v_lshlrev_b32 v2, 1, v2
    v_bfe_u32 v3, v1, 1, 1
    v_or_b32 v2, v2, v3
    v_lshlrev_b32 v2, 4, v2
    v_bfe_u32 v3, v1, 2, 2
    v_lshl_add_u32 v3, v5, 3, v3
    v_lshl_add_u32 v2, v3, 7, v2
    v_and_b32 v3, 1, v1
    v_lshl_add_u32 v2, v3, 3, v2
    s_lshl_b32 s87, s29, 15
    v_add_u32 v234, s87, v2
    v_add_u32 v238, s87, v7
    v_xor_b32 v235, 32, v234
    v_xor_b32 v236, 64, v234
    v_xor_b32 v237, 96, v234
    v_mov_b32 v107, s5
    v_mov_b32 v111, s5
    s_barrier
    buffer_load_dwordx4 v[200:203], v240, s[8:11], s82 offen offset:0 sc1
    buffer_load_dwordx4 v[204:207], v240, s[8:11], s82 offen offset:1024 sc1
    buffer_load_dwordx4 v[208:211], v240, s[8:11], s82 offen offset:2048 sc1
    buffer_load_dwordx4 v[212:215], v240, s[8:11], s83 offen offset:0 sc1
    buffer_load_dwordx4 v[216:219], v240, s[8:11], s83 offen offset:1024 sc1
    buffer_load_dwordx4 v[220:223], v240, s[8:11], s83 offen offset:2048 sc1
    s_waitcnt vmcnt(6)
    ds_write_b128 v238, v[8:11] offset:0
    ds_write_b128 v238, v[12:15] offset:1024
    ds_write_b128 v238, v[16:19] offset:2048
    ds_write_b128 v238, v[20:23] offset:3072
    ds_write_b128 v238, v[24:27] offset:4096
    ds_write_b128 v238, v[28:31] offset:5120
    ds_write_b128 v238, v[32:35] offset:6144
    ds_write_b128 v238, v[36:39] offset:7168
    ds_write_b128 v238, v[40:43] offset:8192
    ds_write_b128 v238, v[44:47] offset:9216
    ds_write_b128 v238, v[48:51] offset:10240
    ds_write_b128 v238, v[52:55] offset:11264
    ds_write_b128 v238, v[56:59] offset:12288
    ds_write_b128 v238, v[60:63] offset:13312
    ds_write_b128 v238, v[64:67] offset:14336
    ds_write_b128 v238, v[68:71] offset:15360
    s_waitcnt lgkmcnt(0)
    ds_read_b64_tr_b16 v[8:9], v234 offset:0
    ds_read_b64_tr_b16 v[10:11], v234 offset:512
    ds_read_b64_tr_b16 v[12:13], v235 offset:0
    ds_read_b64_tr_b16 v[14:15], v235 offset:512
    ds_read_b64_tr_b16 v[16:17], v236 offset:0
    ds_read_b64_tr_b16 v[18:19], v236 offset:512
    ds_read_b64_tr_b16 v[20:21], v237 offset:0
    ds_read_b64_tr_b16 v[22:23], v237 offset:512
    ds_read_b64_tr_b16 v[24:25], v234 offset:4096
    ds_read_b64_tr_b16 v[26:27], v234 offset:4608
    ds_read_b64_tr_b16 v[28:29], v235 offset:4096
    ds_read_b64_tr_b16 v[30:31], v235 offset:4608
    ds_read_b64_tr_b16 v[32:33], v236 offset:4096
    ds_read_b64_tr_b16 v[34:35], v236 offset:4608
    ds_read_b64_tr_b16 v[36:37], v237 offset:4096
    ds_read_b64_tr_b16 v[38:39], v237 offset:4608
    ds_read_b64_tr_b16 v[40:41], v234 offset:8192
    ds_read_b64_tr_b16 v[42:43], v234 offset:8704
    ds_read_b64_tr_b16 v[44:45], v235 offset:8192
    ds_read_b64_tr_b16 v[46:47], v235 offset:8704
    ds_read_b64_tr_b16 v[48:49], v236 offset:8192
    ds_read_b64_tr_b16 v[50:51], v236 offset:8704
    ds_read_b64_tr_b16 v[52:53], v237 offset:8192
    ds_read_b64_tr_b16 v[54:55], v237 offset:8704
    ds_read_b64_tr_b16 v[56:57], v234 offset:12288
    ds_read_b64_tr_b16 v[58:59], v234 offset:12800
    ds_read_b64_tr_b16 v[60:61], v235 offset:12288
    ds_read_b64_tr_b16 v[62:63], v235 offset:12800
    ds_read_b64_tr_b16 v[64:65], v236 offset:12288
    ds_read_b64_tr_b16 v[66:67], v236 offset:12800
    ds_read_b64_tr_b16 v[68:69], v237 offset:12288
    ds_read_b64_tr_b16 v[70:71], v237 offset:12800
    s_waitcnt vmcnt(0)
L_poll_45:
    s_mov_b64 s[0:1], exec
    v_cmpx_eq_u32 vcc, s5, v203
    v_cmpx_eq_u32 vcc, s5, v207
    v_cmpx_eq_u32 vcc, s5, v211
    v_cmpx_eq_u32 vcc, s5, v215
    v_cmpx_eq_u32 vcc, s5, v219
    v_cmpx_eq_u32 vcc, s5, v223
    s_andn2_b64 exec, s[0:1], exec
    s_cbranch_scc0 L_got_46
    buffer_load_dwordx4 v[200:203], v240, s[8:11], s82 offen offset:0 sc1
    buffer_load_dwordx4 v[204:207], v240, s[8:11], s82 offen offset:1024 sc1
    buffer_load_dwordx4 v[208:211], v240, s[8:11], s82 offen offset:2048 sc1
    buffer_load_dwordx4 v[212:215], v240, s[8:11], s83 offen offset:0 sc1
    buffer_load_dwordx4 v[216:219], v240, s[8:11], s83 offen offset:1024 sc1
    buffer_load_dwordx4 v[220:223], v240, s[8:11], s83 offen offset:2048 sc1
    s_sub_u32 s6, s6, 1
    s_cmp_gt_i32 s6, 0
    s_waitcnt vmcnt(0)
    s_cbranch_scc1 L_poll_45
L_got_46:
    s_mov_b64 exec, -1
    s_nop 3
L_A_pg:
    v_mov_b32_dpp v226, v210 quad_perm:[2,3,2,3] row_mask:0xf bank_mask:0xf
    v_mov_b32_dpp v227, v222 quad_perm:[2,3,2,3] row_mask:0xf bank_mask:0xf
    v_mov_b32_dpp v210, v210 quad_perm:[0,1,0,1] row_mask:0xf bank_mask:0xf
    v_mov_b32_dpp v222, v222 quad_perm:[0,1,0,1] row_mask:0xf bank_mask:0xf
    v_max_f32 v2, v210, v222
    s_nop 1
    v_max_f32_dpp v2, v2, v2 row_ror:8 row_mask:0xf bank_mask:0xf
    v_mov_b32 v3, v2
    v_lshlrev_b32 v160, 16, v200
    v_and_b32 v161, 0xffff0000, v200
    v_permlane16_swap_b32 v2, v3
    v_max_f32 v2, v2, v3
    v_mov_b32 v3, v2
    v_lshlrev_b32 v162, 16, v201
    v_and_b32 v163, 0xffff0000, v201
    v_permlane32_swap_b32 v2, v3
    v_max_f32 v2, v2, v3
    v_sub_f32 v224, v210, v2
    v_sub_f32 v225, v222, v2
    v_exp_f32 v224, v224
    v_exp_f32 v225, v225
    v_lshlrev_b32 v164, 16, v202
    v_and_b32 v165, 0xffff0000, v202
    v_mul_f32 v2, v224, v226
    v_fmac_f32 v2, v225, v227
    v_lshlrev_b32 v166, 16, v204
    v_and_b32 v167, 0xffff0000, v204
    v_add_f32_dpp v2, v2, v2 row_ror:8 row_mask:0xf bank_mask:0xf
    v_mov_b32 v3, v2
    v_lshlrev_b32 v168, 16, v205
    v_and_b32 v169, 0xffff0000, v205
    v_permlane16_swap_b32 v2, v3
    v_add_f32 v2, v2, v3
    v_mov_b32 v3, v2
    v_lshlrev_b32 v170, 16, v206
    v_and_b32 v171, 0xffff0000, v206
    v_permlane32_swap_b32 v2, v3
    v_add_f32 v2, v2, v3
    v_rcp_f32 v2, v2
    v_lshlrev_b32 v172, 16, v208
    v_and_b32 v173, 0xffff0000, v208
    v_lshlrev_b32 v174, 16, v209
    v_and_b32 v175, 0xffff0000, v209
    v_pk_mul_f32 v[224:225], v[224:225], v[2:3] op_sel_hi:[1,0]
    v_lshlrev_b32 v176, 16, v212
    v_and_b32 v177, 0xffff0000, v212
    v_lshlrev_b32 v178, 16, v213
    v_and_b32 v179, 0xffff0000, v213
    v_lshlrev_b32 v180, 16, v214
    v_and_b32 v181, 0xffff0000, v214
    v_lshlrev_b32 v182, 16, v216
    v_and_b32 v183, 0xffff0000, v216
    v_lshlrev_b32 v184, 16, v217
    v_and_b32 v185, 0xffff0000, v217
    v_lshlrev_b32 v186, 16, v218
    v_and_b32 v187, 0xffff0000, v218
    v_lshlrev_b32 v188, 16, v220
    v_and_b32 v189, 0xffff0000, v220
    v_lshlrev_b32 v190, 16, v221
    v_and_b32 v191, 0xffff0000, v221
    v_pk_mul_f32 v[160:161], v[160:161], v[224:225] op_sel_hi:[1,0]
    v_pk_mul_f32 v[162:163], v[162:163], v[224:225] op_sel_hi:[1,0]
    v_pk_mul_f32 v[164:165], v[164:165], v[224:225] op_sel_hi:[1,0]
    v_pk_mul_f32 v[166:167], v[166:167], v[224:225] op_sel_hi:[1,0]
    v_pk_mul_f32 v[168:169], v[168:169], v[224:225] op_sel_hi:[1,0]
    v_pk_mul_f32 v[170:171], v[170:171], v[224:225] op_sel_hi:[1,0]
    v_pk_mul_f32 v[172:173], v[172:173], v[224:225] op_sel_hi:[1,0]
    v_pk_mul_f32 v[174:175], v[174:175], v[224:225] op_sel_hi:[1,0]
    v_pk_fma_f32 v[160:161], v[176:177], v[224:225], v[160:161] op_sel:[0,1,0] op_sel_hi:[1,1,1]
    v_pk_fma_f32 v[162:163], v[178:179], v[224:225], v[162:163] op_sel:[0,1,0] op_sel_hi:[1,1,1]
    v_pk_fma_f32 v[164:165], v[180:181], v[224:225], v[164:165] op_sel:[0,1,0] op_sel_hi:[1,1,1]
    v_pk_fma_f32 v[166:167], v[182:183], v[224:225], v[166:167] op_sel:[0,1,0] op_sel_hi:[1,1,1]
    v_pk_fma_f32 v[168:169], v[184:185], v[224:225], v[168:169] op_sel:[0,1,0] op_sel_hi:[1,1,1]
    v_pk_fma_f32 v[170:171], v[186:187], v[224:225], v[170:171] op_sel:[0,1,0] op_sel_hi:[1,1,1]
    v_pk_fma_f32 v[172:173], v[188:189], v[224:225], v[172:173] op_sel:[0,1,0] op_sel_hi:[1,1,1]
    v_pk_fma_f32 v[174:175], v[190:191], v[224:225], v[174:175] op_sel:[0,1,0] op_sel_hi:[1,1,1]
    v_permlane32_swap_b32 v160, v168
    v_permlane32_swap_b32 v161, v169
    v_permlane32_swap_b32 v162, v170
    v_permlane32_swap_b32 v163, v171
    v_permlane32_swap_b32 v164, v172
    v_permlane32_swap_b32 v165, v173
    v_permlane32_swap_b32 v166, v174
    v_permlane32_swap_b32 v167, v175
    v_pk_add_f32 v[160:161], v[160:161], v[168:169]
    v_pk_add_f32 v[162:163], v[162:163], v[170:171]
    v_pk_add_f32 v[164:165], v[164:165], v[172:173]
    v_pk_add_f32 v[166:167], v[166:167], v[174:175]
    s_nop 0
    v_permlane16_swap_b32 v160, v164
    v_permlane16_swap_b32 v161, v165
    v_permlane16_swap_b32 v162, v166
    v_permlane16_swap_b32 v163, v167
    v_pk_add_f32 v[160:161], v[160:161], v[164:165]
    v_pk_add_f32 v[162:163], v[162:163], v[166:167]
    s_nop 0
    v_add_f32_dpp v164, v160, v160 row_ror:8 row_mask:0xf bank_mask:0xf
    v_add_f32_dpp v165, v161, v161 row_ror:8 row_mask:0xf bank_mask:0xf
    v_add_f32_dpp v166, v162, v162 row_ror:8 row_mask:0xf bank_mask:0xf
    v_add_f32_dpp v167, v163, v163 row_ror:8 row_mask:0xf bank_mask:0xf
    v_cvt_pk_bf16_f32 v104, v164, v165
    v_cvt_pk_bf16_f32 v105, v166, v167
    s_mov_b64 exec, s[96:97]
    buffer_store_dwordx4 v[104:107], v241, s[8:11], s84 offen sc1
    s_mov_b64 exec, -1
    s_cmp_lt_u32 s3, 4
    s_cbranch_scc1 L_A_s5
    buffer_load_dwordx4 v[200:203], v232, s[8:11], s85 offen offset:0 sc1
    buffer_load_dwordx4 v[204:207], v232, s[8:11], s85 offen offset:128 sc1
    buffer_load_dwordx4 v[208:211], v232, s[8:11], s85 offen offset:256 sc1
    buffer_load_dwordx4 v[212:215], v232, s[8:11], s85 offen offset:384 sc1
    s_waitcnt vmcnt(0)
L_poll_47:
    s_mov_b64 s[0:1], exec
    v_cmpx_eq_u32 vcc, s5, v203
    v_cmpx_eq_u32 vcc, s5, v207
    v_cmpx_eq_u32 vcc, s5, v211
    v_cmpx_eq_u32 vcc, s5, v215
    s_andn2_b64 exec, s[0:1], exec
    s_cbranch_scc0 L_got_48
    buffer_load_dwordx4 v[200:203], v232, s[8:11], s85 offen offset:0 sc1
    buffer_load_dwordx4 v[204:207], v232, s[8:11], s85 offen offset:128 sc1
    buffer_load_dwordx4 v[208:211], v232, s[8:11], s85 offen offset:256 sc1
    buffer_load_dwordx4 v[212:215], v232, s[8:11], s85 offen offset:384 sc1
    s_sub_u32 s6, s6, 1
    s_cmp_gt_i32 s6, 0
    s_waitcnt vmcnt(0)
    s_cbranch_scc1 L_poll_47
L_got_48:
    s_mov_b64 exec, -1
    s_nop 3
    s_waitcnt lgkmcnt(0)
    v_mov_b32_dpp v202, v200 row_ror:8 row_mask:0xf bank_mask:0xf
    v_mov_b32_dpp v203, v201 row_ror:8 row_mask:0xf bank_mask:0xf
    v_mov_b32_dpp v206, v204 row_ror:8 row_mask:0xf bank_mask:0xf
    v_mov_b32_dpp v207, v205 row_ror:8 row_mask:0xf bank_mask:0xf
    v_mov_b32_dpp v210, v208 row_ror:8 row_mask:0xf bank_mask:0xf
    v_mov_b32_dpp v211, v209 row_ror:8 row_mask:0xf bank_mask:0xf
    v_mov_b32_dpp v214, v212 row_ror:8 row_mask:0xf bank_mask:0xf
    v_mov_b32_dpp v215, v213 row_ror:8 row_mask:0xf bank_mask:0xf
    v_mfma_f32_16x16x32_bf16 v[216:219], v[8:11], v[200:203], 0
    v_mfma_f32_16x16x32_bf16 v[220:223], v[12:15], v[200:203], 0
    v_mfma_f32_16x16x32_bf16 v[224:227], v[16:19], v[200:203], 0
    v_mfma_f32_16x16x32_bf16 v[228:231], v[20:23], v[200:203], 0
    v_mfma_f32_16x16x32_bf16 v[216:219], v[24:27], v[204:207], v[216:219]
    v_mfma_f32_16x16x32_bf16 v[220:223], v[28:31], v[204:207], v[220:223]
    v_mfma_f32_16x16x32_bf16 v[224:227], v[32:35], v[204:207], v[224:227]
    v_mfma_f32_16x16x32_bf16 v[228:231], v[36:39], v[204:207], v[228:231]
    v_mfma_f32_16x16x32_bf16 v[216:219], v[40:43], v[208:211], v[216:219]
    v_mfma_f32_16x16x32_bf16 v[220:223], v[44:47], v[208:211], v[220:223]
    v_mfma_f32_16x16x32_bf16 v[224:227], v[48:51], v[208:211], v[224:227]
    v_mfma_f32_16x16x32_bf16 v[228:231], v[52:55], v[208:211], v[228:231]
    v_mfma_f32_16x16x32_bf16 v[216:219], v[56:59], v[212:215], v[216:219]
    v_mfma_f32_16x16x32_bf16 v[220:223], v[60:63], v[212:215], v[220:223]
    v_mfma_f32_16x16x32_bf16 v[224:227], v[64:67], v[212:215], v[224:227]
    v_mfma_f32_16x16x32_bf16 v[228:231], v[68:71], v[212:215], v[228:231]
    s_nop 4
    v_cvt_pk_bf16_f32 v160, v216, v217
    v_cvt_pk_bf16_f32 v161, v218, v219
    v_cvt_pk_bf16_f32 v162, v220, v221
    v_cvt_pk_bf16_f32 v163, v222, v223
    v_cvt_pk_bf16_f32 v164, v224, v225
    v_cvt_pk_bf16_f32 v165, v226, v227
    v_cvt_pk_bf16_f32 v166, v228, v229
    v_cvt_pk_bf16_f32 v167, v230, v231
    s_mov_b64 exec, s[96:97]
    ds_write_b128 v233, v[160:163] offset:0
    ds_write_b128 v233, v[164:167] offset:512
    s_mov_b64 exec, -1
    s_waitcnt lgkmcnt(0)
    s_branch L_A_s5b
L_A_s5:
    s_waitcnt vmcnt(0)
L_A_s5b:
    s_barrier
    ds_read_b128 v[88:91], v242 offset:0
    ds_read_b64_tr_b16 v[72:73], v244 offset:0
    ds_read_b64_tr_b16 v[74:75], v244 offset:32768
    ds_read_b64_tr_b16 v[80:81], v246 offset:0
    ds_read_b64_tr_b16 v[82:83], v246 offset:32768
    ds_read_b128 v[92:95], v242 offset:512
    ds_read_b64_tr_b16 v[76:77], v245 offset:0
    ds_read_b64_tr_b16 v[78:79], v245 offset:32768
    ds_read_b64_tr_b16 v[84:85], v247 offset:0
    ds_read_b64_tr_b16 v[86:87], v247 offset:32768
    ds_read_b128 v[96:99], v242 offset:1024
    ds_read_b128 v[100:103], v242 offset:1536
    s_waitcnt lgkmcnt(7)
    v_mfma_f32_16x16x32_bf16 v[160:163], v[72:75], v[88:91], 0
    v_mfma_f32_16x16x32_bf16 v[164:167], v[80:83], v[88:91], 0
    s_waitcnt lgkmcnt(2)
    v_mfma_f32_16x16x32_bf16 v[160:163], v[76:79], v[92:95], v[160:163]
    v_mfma_f32_16x16x32_bf16 v[164:167], v[84:87], v[92:95], v[164:167]
    s_waitcnt lgkmcnt(1)
    v_mfma_f32_16x16x32_bf16 v[160:163], v[72:75], v[96:99], v[160:163]
    v_mfma_f32_16x16x32_bf16 v[164:167], v[80:83], v[96:99], v[164:167]
    s_waitcnt lgkmcnt(0)
    v_mfma_f32_16x16x32_bf16 v[160:163], v[76:79], v[100:103], v[160:163]
    v_mfma_f32_16x16x32_bf16 v[164:167], v[84:87], v[100:103], v[164:167]
    s_nop 6
    v_add_f32_dpp v168, v160, v160 row_ror:8 row_mask:0xf bank_mask:0x3
    v_add_f32_dpp v169, v161, v161 row_ror:8 row_mask:0xf bank_mask:0x3
    v_add_f32_dpp v170, v162, v162 row_ror:8 row_mask:0xf bank_mask:0x3
    v_add_f32_dpp v171, v163, v163 row_ror:8 row_mask:0xf bank_mask:0x3
    v_add_f32_dpp v168, v164, v164 row_ror:8 row_mask:0xf bank_mask:0xc
    v_add_f32_dpp v169, v165, v165 row_ror:8 row_mask:0xf bank_mask:0xc
    v_add_f32_dpp v170, v166, v166 row_ror:8 row_mask:0xf bank_mask:0xc
    v_add_f32_dpp v171, v167, v167 row_ror:8 row_mask:0xf bank_mask:0xc
    v_perm_b32 v108, v168, v171, s92
    v_perm_b32 v109, v169, v171, s93
    v_perm_b32 v110, v170, v171, s94
    buffer_store_dwordx4 v[108:111], v243, s[8:11], s86 offen sc1
L_S6:
    s_cmp_lg_u32 s3, 7
    s_cbranch_scc1 L_fin
    s_lshl3_add_u32 s78, s4, s7
    s_mul_i32 s80, s78, 0x3000
    s_bfe_u32 s79, s2, 0x10003
    s_lshl_b32 s81, s79, 6
    s_add_u32 s80, s80, s81
    s_add_u32 s80, s80, 2621440
    s_add_u32 s81, s80, 4096
    s_add_u32 s82, s80, 8192
    v_lshrrev_b32 v2, 2, v1
    v_lshlrev_b32 v2, 7, v2
    v_and_b32 v3, 3, v1
    v_lshl_add_u32 v2, v3, 4, v2
    buffer_load_dwordx4 v[80:83], v2, s[8:11], s80 offen offset:0 sc1
    buffer_load_dwordx4 v[84:87], v2, s[8:11], s80 offen offset:2048 sc1
    buffer_load_dwordx4 v[88:91], v2, s[8:11], s81 offen offset:0 sc1
    buffer_load_dwordx4 v[92:95], v2, s[8:11], s81 offen offset:2048 sc1
    buffer_load_dwordx4 v[96:99], v2, s[8:11], s82 offen offset:0 sc1
    buffer_load_dwordx4 v[100:103], v2, s[8:11], s82 offen offset:2048 sc1
    v_lshlrev_b32 v3, 10, v3
    v_lshl_add_u32 v3, v5, 1, v3
    s_lshl_b32 s79, s79, 12
    s_lshl3_add_u32 s79, s78, s79
    v_sub_f32 v104, 1.0, v250
    s_waitcnt vmcnt(0)
L_poll_49:
    s_mov_b64 s[0:1], exec
    v_cmpx_eq_u32 vcc, s5, v99
    v_cmpx_eq_u32 vcc, s5, v103
    s_andn2_b64 exec, s[0:1], exec
    s_cbranch_scc0 L_got_50
    buffer_load_dwordx4 v[96:99], v2, s[8:11], s82 offen offset:0 sc1
    buffer_load_dwordx4 v[100:103], v2, s[8:11], s82 offen offset:2048 sc1
    s_sub_u32 s6, s6, 1
    s_cmp_gt_i32 s6, 0
    s_waitcnt vmcnt(0)
    s_cbranch_scc1 L_poll_49
L_got_50:
    s_mov_b64 exec, -1
    s_nop 3
    v_perm_b32 v99, v97, v96, s90
    v_perm_b32 v99, v98, v99, s91
    v_perm_b32 v103, v101, v100, s90
    v_perm_b32 v103, v102, v103, s91
    v_pk_add_f32 v[96:97], v[96:97], v[100:101]
    v_pk_add_f32 v[98:99], v[98:99], v[102:103]
    v_pk_mul_f32 v[96:97], v[96:97], v[104:105] op_sel_hi:[1,0]
    v_pk_mul_f32 v[98:99], v[98:99], v[104:105] op_sel_hi:[1,0]
L_poll_51:
    s_mov_b64 s[0:1], exec
    v_cmpx_eq_u32 vcc, s5, v83
    v_cmpx_eq_u32 vcc, s5, v87
    v_cmpx_eq_u32 vcc, s5, v91
    v_cmpx_eq_u32 vcc, s5, v95
    s_andn2_b64 exec, s[0:1], exec
    s_cbranch_scc0 L_got_52
    buffer_load_dwordx4 v[80:83], v2, s[8:11], s80 offen offset:0 sc1
    buffer_load_dwordx4 v[84:87], v2, s[8:11], s80 offen offset:2048 sc1
    buffer_load_dwordx4 v[88:91], v2, s[8:11], s81 offen offset:0 sc1
    buffer_load_dwordx4 v[92:95], v2, s[8:11], s81 offen offset:2048 sc1
    s_sub_u32 s6, s6, 1
    s_cmp_gt_i32 s6, 0
    s_waitcnt vmcnt(0)
    s_cbranch_scc1 L_poll_51
L_got_52:
    s_mov_b64 exec, -1
    s_nop 3
    v_perm_b32 v83, v81, v80, s90
    v_perm_b32 v83, v82, v83, s91
    v_perm_b32 v87, v85, v84, s90
    v_perm_b32 v87, v86, v87, s91
    v_perm_b32 v91, v89, v88, s90
    v_perm_b32 v91, v90, v91, s91
    v_perm_b32 v95, v93, v92, s90
    v_perm_b32 v95, v94, v95, s91
    v_pk_add_f32 v[80:81], v[80:81], v[84:85]
    v_pk_add_f32 v[88:89], v[88:89], v[92:93]
    v_pk_add_f32 v[82:83], v[82:83], v[86:87]
    v_pk_add_f32 v[90:91], v[90:91], v[94:95]
    v_pk_add_f32 v[80:81], v[80:81], v[88:89]
    v_pk_add_f32 v[82:83], v[82:83], v[90:91]
    v_pk_fma_f32 v[88:89], v[80:81], v[250:251], v[96:97] op_sel_hi:[1,0,1]
    v_pk_fma_f32 v[90:91], v[82:83], v[250:251], v[98:99] op_sel_hi:[1,0,1]
    s_nop 1
    v_permlane32_swap_b32 v88, v90
    v_permlane32_swap_b32 v89, v91
    v_pk_add_f32 v[88:89], v[88:89], v[90:91]
    s_nop 1
    v_permlane16_swap_b32 v88, v89
    v_add_f32 v88, v88, v89
    s_nop 1
    v_add_f32_dpp v88, v88, v88 row_ror:4 row_mask:0xf bank_mask:0xf
    s_nop 1
    v_add_f32_dpp v88, v88, v88 row_ror:8 row_mask:0xf bank_mask:0xf
    v_cvt_pk_bf16_f32 v88, v88, v88
    s_mov_b32 exec_lo, 0x000f000f
    s_mov_b32 exec_hi, 0x000f000f
    buffer_store_short v88, v3, s[40:43], s79 offen
    s_cmp_lg_u32 s2, 0
    s_cbranch_scc1 L_fin
    s_mov_b64 exec, 1
    v_mov_b32 v2, 0
    v_mov_b32 v3, s5
    buffer_store_dword v3, v2, s[8:11], 0 offen sc1
L_fin:
L_end:
s_endpgm
.section .rodata,"a"
.p2align 6
.amdhsa_kernel gated_mix__compressed_kv_cla__sliding_block_cached__decode_kernel
  .amdhsa_next_free_vgpr 256
  .amdhsa_next_free_sgpr 102
  .amdhsa_accum_offset 256
  .amdhsa_group_segment_fixed_size 0
  .amdhsa_kernarg_size 120
  .amdhsa_user_sgpr_count 2
  .amdhsa_user_sgpr_kernarg_segment_ptr 1
  .amdhsa_system_sgpr_workgroup_id_x 1
.end_amdhsa_kernel
```
